```python
import torch

def _softmax(x, axis=-1):
    return torch.softmax(x, dim=axis)
def _gelu(x):
    return torch.nn.functional.gelu(x, approximate="tanh")
def _silu(x):
    return torch.nn.functional.silu(x)
def _sigmoid(x):
    return torch.sigmoid(x)
def _layernorm(x, axis=-1, eps=1e-5):
    m = x.mean(dim=axis, keepdim=True)
    v = x.var(dim=axis, keepdim=True, unbiased=False)
    return (x - m) / torch.sqrt(v + eps)
def _scatter_add(tgt, idx, src, axis=0):
    return tgt.clone().index_add_(axis, idx, src)
def _segment_sum(src, seg, n):
    out = torch.zeros((n,) + src.shape[1:], dtype=src.dtype)
    return out.index_add_(0, seg, src)
def _pad(x, pw):
    flat = tuple(v for pair in reversed(pw) for v in pair)
    return torch.nn.functional.pad(x, flat)

kernel_name = 'sequential_preLN__linear_kernel_hedgehog__glu_gated_geglu__prompt'

def setup_inputs():

    _w = (lambda a: (lambda t: t.to(torch.bfloat16) if t.is_floating_point() else t)(torch.as_tensor(a)))
    def _A_setup():
        B, S, D, H = 1, 2048, 448, 16
        Dh = D // H
        return {
            "x": _w((lambda *s: torch.randn(*s, dtype=torch.bfloat16) * 0.05)(B, S, D)),
            "wqkv": _w((lambda *s: torch.randn(*s, dtype=torch.bfloat16) * 0.2)(D, 3 * D)),
            "w_phi": _w((lambda *s: torch.randn(*s, dtype=torch.bfloat16) * 0.2)(H, Dh, Dh) * (Dh ** -0.5)),
            "wo": _w((lambda *s: torch.randn(*s, dtype=torch.bfloat16) * 0.05)(D, D)),
        }
    _A_in = _A_setup()

    def _B_setup():
        B, S, Dm, Df = 1, 2048, 448, 1792
        return {
            "x": _w((lambda *s: torch.randn(*s, dtype=torch.bfloat16) * 0.05)(B, S, Dm)),
            "w_gate": _w((lambda *s: torch.randn(*s, dtype=torch.bfloat16) * 0.4)(Dm, Df) * (Dm ** -0.5)),
            "w_up": _w((lambda *s: torch.randn(*s, dtype=torch.bfloat16) * 0.4)(Dm, Df) * (Dm ** -0.5)),
            "w_down": _w((lambda *s: torch.randn(*s, dtype=torch.bfloat16) * 0.4)(Df, Dm) * (Df ** -0.5)),
        }
    _B_in = _B_setup()

    return {
        "A_x": _A_in["x"],
        "A_wqkv": _A_in["wqkv"],
        "A_w_phi": _A_in["w_phi"],
        "A_wo": _A_in["wo"],
        "B_x": _B_in["x"],
        "B_w_gate": _B_in["w_gate"],
        "B_w_up": _B_in["w_up"],
        "B_w_down": _B_in["w_down"],
    }

def reference(A_x, A_wqkv, A_w_phi, A_wo, B_x, B_w_gate, B_w_up, B_w_down):
    def _A_ref(x, wqkv, w_phi, wo):
        B, S, D = x.shape
        H = 16; Dh = D // H
        qkv = (lambda x, *d: x.permute(*d))((x @ wqkv).reshape(B, S, 3, H, Dh), 2, 0, 3, 1, 4)
        q, k, v = qkv[0], qkv[1], qkv[2]
        pq = torch.einsum("bhsd,hdf->bhsf", q, w_phi)
        pk = torch.einsum("bhsd,hdf->bhsf", k, w_phi)
        phi_q = torch.concatenate([_softmax(pq, axis=-1), _softmax(-pq, axis=-1)], axis=-1)
        phi_k = torch.concatenate([_softmax(pk, axis=-1), _softmax(-pk, axis=-1)], axis=-1)
        kv = torch.einsum("bhsf,bhsd->bhfd", phi_k, v)
        z  = torch.einsum("bhsf->bhf", phi_k)
        num = torch.einsum("bhqf,bhfd->bhqd", phi_q, kv)
        den = torch.einsum("bhqf,bhf->bhq", phi_q, z)[..., None] + 1e-6
        o = num / den
        return (lambda x, *d: x.permute(*d))(o, 0, 2, 1, 3).reshape(B, S, D) @ wo

    def _B_ref(x, w_gate, w_up, w_down):
        g = torch.einsum("bsd,df->bsf", x, w_gate)
        u = torch.einsum("bsd,df->bsf", x, w_up)
        h = _gelu(g) * u
        return torch.einsum("bsf,fd->bsd", h, w_down)

    x = A_x
    h = x + _A_ref(_layernorm(x, axis=-1), A_wqkv, A_w_phi, A_wo)
    h2 = h + _B_ref(_layernorm(h, axis=-1), B_w_gate, B_w_up, B_w_down)
    return h2
```

```asm
; @launch grid=(256,1,1) block=(256,1,1) lds=163840
.amdgcn_target "amdgcn-amd-amdhsa--gfx950"
.text
.p2align 8
.globl sequential_preLN__linear_kernel_hedgehog__glu_gated_geglu__prompt_kernel
.type sequential_preLN__linear_kernel_hedgehog__glu_gated_geglu__prompt_kernel,@function
sequential_preLN__linear_kernel_hedgehog__glu_gated_geglu__prompt_kernel:
    s_cmp_ge_u32 s2, 256
    s_cbranch_scc1 L_end
    s_load_dwordx2 s[40:41], s[0:1], 0
    s_load_dwordx2 s[44:45], s[0:1], 8
    s_load_dwordx2 s[72:73], s[0:1], 80
    s_load_dwordx2 s[48:49], s[0:1], 16
    s_load_dwordx2 s[52:53], s[0:1], 24
    s_load_dwordx2 s[60:61], s[0:1], 56
    s_load_dwordx2 s[64:65], s[0:1], 64
    s_load_dwordx2 s[68:69], s[0:1], 72
    s_load_dwordx4 s[84:87], s[0:1], 40
    s_mov_b32 s42, 0x1c0000
    s_mov_b32 s43, 0x20000
    s_mov_b32 s46, 0x126000
    s_mov_b32 s47, 0x20000
    s_mov_b32 s74, 0x1e00000
    s_mov_b32 s75, 0x20000
    s_mov_b32 s50, 0x6200
    s_mov_b32 s51, 0x20000
    s_mov_b32 s54, 0x62000
    s_mov_b32 s55, 0x20000
    s_mov_b32 s58, 0x188000
    s_mov_b32 s59, 0x20000
    s_mov_b32 s62, 0x188000
    s_mov_b32 s63, 0x20000
    s_mov_b32 s66, 0x1c0000
    s_mov_b32 s67, 0x20000
    s_mov_b32 s70, 0x100
    s_mov_b32 s71, 0x20000
    v_lshrrev_b32 v7, 6, v0
    v_and_b32 v1, 63, v0
    v_readfirstlane_b32 s4, v7
    v_lshlrev_b32 v2, 4, v1
    v_and_b32 v3, 31, v1
    v_lshrrev_b32 v4, 5, v1
    v_mov_b32 v5, 0
    s_and_b32 s5, s2, 3
    s_lshl_b32 s5, s5, 2
    s_bfe_u32 s7, s2, 0x20003
    s_add_u32 s5, s5, s7
    s_lshr_b32 s6, s2, 5
    s_bfe_u32 s7, s2, 0x10002
    s_lshl_b32 s7, s7, 3
    s_add_u32 s6, s6, s7
    v_lshrrev_b32 v7, 3, v1
    v_mul_u32_u24 v219, 896, v7
    v_lshrrev_b32 v7, 4, v1
    v_and_b32 v220, 7, v1
    v_xor_b32 v8, v220, v7
    v_lshl_add_u32 v216, v8, 4, v219
    v_xor_b32 v8, 4, v8
    v_lshl_add_u32 v217, v8, 4, v219
    v_and_b32 v7, 1, v7
    v_lshlrev_b32 v7, 2, v7
    v_xor_b32 v8, v220, v7
    v_lshl_add_u32 v221, v8, 4, v219
    v_lshrrev_b32 v7, 2, v1
    v_mul_u32_u24 v218, 2688, v7
    v_and_b32 v8, 3, v1
    v_lshlrev_b32 v8, 4, v8
    v_min_u32 v8, 40, v8
    v_add_u32 v218, v218, v8
    v_lshlrev_b32 v222, 7, v1
    s_lshl_b32 s10, s4, 12
    s_lshl_b32 s11, s4, 10
    s_lshl_b32 s20, s5, 2
    s_add_u32 s20, s20, s4
    s_mul_i32 s23, s20, 28672
    s_mul_i32 s24, s4, 43008
    s_mul_i32 s7, s6, 56
    s_add_u32 s24, s24, s7
    s_lshl_b32 s21, s6, 8
    s_add_u32 s21, s21, 0x1580000
    s_lshl_b32 s22, s5, 8
    s_add_u32 s22, s22, 0x1581000
    s_lshl_b32 s29, s5, 4
    s_add_u32 s29, s29, s6
    s_lshl_b32 s12, s29, 2
    s_add_u32 s12, s12, s4
    s_waitcnt lgkmcnt(0)
    s_cmp_lg_u32 s4, 0
    s_cbranch_scc1 L_sequential_preLN__linear_kernel_hedgehog__glu_gated_geglu__prompt_kernel_2
    s_mov_b64 s[30:31], exec
    s_mov_b64 exec, 15
    s_cmp_lg_u32 s5, 0
    s_cbranch_scc1 L_sequential_preLN__linear_kernel_hedgehog__glu_gated_geglu__prompt_kernel_1
    v_lshlrev_b32 v8, 2, v1
    buffer_store_dword v5, v8, s[72:75], s21 offen sc1
L_sequential_preLN__linear_kernel_hedgehog__glu_gated_geglu__prompt_kernel_1:
    s_cmp_lg_u32 s6, 0
    s_cbranch_scc1 L_sequential_preLN__linear_kernel_hedgehog__glu_gated_geglu__prompt_kernel_3
    v_lshlrev_b32 v8, 2, v1
    buffer_store_dword v5, v8, s[72:75], s22 offen sc1
L_sequential_preLN__linear_kernel_hedgehog__glu_gated_geglu__prompt_kernel_3:
    s_mov_b64 exec, s[30:31]
L_sequential_preLN__linear_kernel_hedgehog__glu_gated_geglu__prompt_kernel_2:
    s_lshl_b32 s12, s29, 2
    s_add_u32 s12, s12, s4
    s_mov_b32 s98, s12
    s_mul_i32 s9, s12, 1792
    s_mov_b64 s[30:31], exec
    s_mov_b64 exec, 0x3fff
    buffer_load_dword a248, v222, s[40:43], s9 offen
    s_mov_b64 exec, s[30:31]
    s_mul_i32 s9, s12, 1280
    s_mov_b64 s[30:31], exec
    s_mov_b64 exec, 0x3ff
    buffer_load_dword a249, v222, s[44:47], s9 offen
    s_mov_b64 exec, s[30:31]
    s_add_u32 s35, s24, 896
    s_add_u32 m0, s11, 16384
    s_nop 0
    buffer_load_dwordx4 v218, s[44:47], s35 offen lds
    s_add_u32 s35, s23, 0
    s_add_u32 m0, s10, 0
    s_nop 0
    buffer_load_dwordx4 v216, s[40:43], s35 offen lds
    s_add_u32 s35, s23, 7168
    s_add_u32 m0, s10, 1024
    s_nop 0
    buffer_load_dwordx4 v217, s[40:43], s35 offen lds
    s_add_u32 s35, s24, 1792
    s_add_u32 m0, s11, 20480
    s_nop 0
    buffer_load_dwordx4 v218, s[44:47], s35 offen lds
    s_add_u32 s35, s23, 14336
    s_add_u32 m0, s10, 2048
    s_nop 0
    buffer_load_dwordx4 v216, s[40:43], s35 offen lds
    s_add_u32 s35, s23, 21504
    s_add_u32 m0, s10, 3072
    s_nop 0
    buffer_load_dwordx4 v217, s[40:43], s35 offen lds
    s_and_b32 s7, s4, 1
    s_lshl_b32 s7, s7, 10
    s_add_u32 m0, s7, 147456
    s_mul_i32 s9, s6, 1568
    s_add_u32 s9, s9, s7
    buffer_load_dwordx4 v2, s[48:51], s9 offen lds
    s_getpc_b64 s[76:77]
L_pc:
    s_sub_u32 s76, s76, L_pc-sequential_preLN__linear_kernel_hedgehog__glu_gated_geglu__prompt_kernel
    s_subb_u32 s77, s77, 0
    s_lshr_b32 s7, s2, 3
    s_lshl_b32 s7, s7, 2
    s_add_u32 s7, s7, s4
    s_mul_i32 s7, s7, 384
    v_add_u32 v8, s7, v222
    v_min_u32 v8, L_end-sequential_preLN__linear_kernel_hedgehog__glu_gated_geglu__prompt_kernel, v8
    s_mov_b64 s[30:31], exec
    s_mov_b64 exec, 7
    global_load_dword a250, v8, s[76:77]
    s_mov_b64 exec, s[30:31]
    s_cmp_lt_u32 s4, 2
    s_cselect_b32 s56, s84, s86
    s_cselect_b32 s57, s85, s87
    s_and_b32 s7, s4, 1
    s_mul_i32 s8, s7, 192
    s_mov_b32 s7, 4682
    v_add_u32 v7, s8, v1
    v_mul_u32_u24 v8, s7, v7
    v_lshrrev_b32 v8, 16, v8
    v_mul_u32_u24 v219, 14, v8
    v_sub_u32 v7, v7, v219
    v_mul_u32_u24 v8, 3584, v8
    v_lshl_add_u32 v248, v7, 4, v8
    v_add_u32 v7, s8, v1
    v_add_u32 v7, 64, v7
    v_mul_u32_u24 v8, s7, v7
    v_lshrrev_b32 v8, 16, v8
    v_mul_u32_u24 v219, 14, v8
    v_sub_u32 v7, v7, v219
    v_mul_u32_u24 v8, 3584, v8
    v_lshl_add_u32 v249, v7, 4, v8
    v_add_u32 v7, s8, v1
    v_add_u32 v7, 128, v7
    v_mul_u32_u24 v8, s7, v7
    v_lshrrev_b32 v8, 16, v8
    v_mul_u32_u24 v219, 14, v8
    v_sub_u32 v7, v7, v219
    v_mul_u32_u24 v8, 3584, v8
    v_lshl_add_u32 v250, v7, 4, v8
    v_add_u32 v7, s8, v1
    v_add_u32 v7, 192, v7
    v_mul_u32_u24 v8, s7, v7
    v_lshrrev_b32 v8, 16, v8
    v_mul_u32_u24 v219, 14, v8
    v_sub_u32 v7, v7, v219
    v_mul_u32_u24 v8, 3584, v8
    v_lshl_add_u32 v251, v7, 4, v8
    s_mov_b32 s16, 0x3fb8aa3b
    s_mov_b32 s17, 0x3f803f80
    s_mov_b32 s18, 0x00003f80
    s_mov_b32 s19, 0x3f800000
    v_cmp_eq_u32 s[32:33], 0, v4
    s_nop 1
    v_cndmask_b32 v6, 0, 1.0, s[32:33]
    v_bfe_u32 v7, v3, 1, 3
    v_xor_b32 v7, v7, v4
    v_lshlrev_b32 v7, 4, v7
    v_lshl_add_u32 v7, v3, 7, v7
    v_add_u32 v7, s10, v7
    v_bfe_u32 v8, v1, 2, 2
    v_lshl_add_u32 v8, v4, 3, v8
    v_lshlrev_b32 v8, 6, v8
    v_and_b32 v219, 3, v1
    v_bfe_u32 v220, v1, 4, 1
    v_lshl_add_u32 v219, v220, 2, v219
    v_xor_b32 v220, 1, v219
    v_cmp_lt_u32 vcc, 5, v219
    s_nop 1
    v_cndmask_b32 v219, v219, v220, vcc
    v_lshl_add_u32 v8, v219, 3, v8
    s_add_u32 s7, s4, 0
    s_and_b32 s7, s7, 3
    s_lshl_b32 s8, s7, 5
    v_xor_b32 v208, s8, v7
    s_lshl_b32 s8, s7, 10
    s_add_u32 s8, s8, 16384
    v_add_u32 v212, s8, v8
    s_add_u32 s7, s4, 1
    s_and_b32 s7, s7, 3
    s_lshl_b32 s8, s7, 5
    v_xor_b32 v209, s8, v7
    s_lshl_b32 s8, s7, 10
    s_add_u32 s8, s8, 16384
    v_add_u32 v213, s8, v8
    s_add_u32 s7, s4, 2
    s_and_b32 s7, s7, 3
    s_lshl_b32 s8, s7, 5
    v_xor_b32 v210, s8, v7
    s_lshl_b32 s8, s7, 10
    s_add_u32 s8, s8, 16384
    v_add_u32 v214, s8, v8
    s_add_u32 s7, s4, 3
    s_and_b32 s7, s7, 3
    s_lshl_b32 s8, s7, 5
    v_xor_b32 v211, s8, v7
    s_lshl_b32 s8, s7, 10
    s_add_u32 s8, s8, 16384
    v_add_u32 v215, s8, v8
    v_mov_b32 v9, 0
    v_mov_b32 v10, 0
    v_mov_b32 v11, 0
    v_mov_b32 v12, 0
    v_mov_b32 v13, 0
    s_add_u32 s35, s24, 172928
    s_add_u32 m0, s11, 40960
    s_nop 0
    buffer_load_dwordx4 v218, s[44:47], s35 offen lds
    s_add_u32 s35, s23, 128
    s_add_u32 m0, s10, 24576
    s_nop 0
    buffer_load_dwordx4 v216, s[40:43], s35 offen lds
    s_add_u32 s35, s23, 7296
    s_add_u32 m0, s10, 25600
    s_nop 0
    buffer_load_dwordx4 v217, s[40:43], s35 offen lds
    s_add_u32 s35, s24, 173824
    s_add_u32 m0, s11, 45056
    s_nop 0
    buffer_load_dwordx4 v218, s[44:47], s35 offen lds
    s_add_u32 s35, s23, 14464
    s_add_u32 m0, s10, 26624
    s_nop 0
    buffer_load_dwordx4 v216, s[40:43], s35 offen lds
    s_add_u32 s35, s23, 21632
    s_add_u32 m0, s10, 27648
    s_nop 0
    buffer_load_dwordx4 v217, s[40:43], s35 offen lds
    s_waitcnt vmcnt(16)
    v_mov_b32 v255, 1
    s_cmp_lg_u32 s4, 0
    s_cbranch_scc1 L_sequential_preLN__linear_kernel_hedgehog__glu_gated_geglu__prompt_kernel_5
    s_mov_b64 s[30:31], exec
    s_mov_b64 exec, 1
    s_cmp_lg_u32 s5, 0
    s_cbranch_scc1 L_sequential_preLN__linear_kernel_hedgehog__glu_gated_geglu__prompt_kernel_4
    s_lshl_b32 s7, s6, 2
    buffer_store_dword v255, off, s[68:71], s7 offset:0 sc1
L_sequential_preLN__linear_kernel_hedgehog__glu_gated_geglu__prompt_kernel_4:
    s_cmp_lg_u32 s6, 0
    s_cbranch_scc1 L_sequential_preLN__linear_kernel_hedgehog__glu_gated_geglu__prompt_kernel_6
    s_lshl_b32 s7, s5, 2
    buffer_store_dword v255, off, s[68:71], s7 offset:64 sc1
L_sequential_preLN__linear_kernel_hedgehog__glu_gated_geglu__prompt_kernel_6:
    s_mov_b64 exec, s[30:31]
L_sequential_preLN__linear_kernel_hedgehog__glu_gated_geglu__prompt_kernel_5:
    s_and_b32 s88, s2, 7
    s_lshl_b32 s88, s88, 1
    s_bfe_u32 s7, s2, 0x10003
    s_add_u32 s88, s88, s7
    s_lshr_b32 s89, s2, 4
    s_and_b32 s90, s2, 3
    s_lshl_b32 s90, s90, 2
    s_bfe_u32 s7, s2, 0x20003
    s_add_u32 s90, s90, s7
    s_lshr_b32 s91, s2, 5
    s_bfe_u32 s7, s2, 0x10002
    s_lshl_b32 s7, s7, 3
    s_add_u32 s91, s91, s7
    s_lshl_b32 s92, s90, 2
    s_add_u32 s92, s92, s4
    s_lshl_b32 s93, s88, 8
    s_add_u32 s93, s93, 0x1581000
    s_lshl_b32 s94, s90, 8
    s_add_u32 s94, s94, 0x1581000
    s_cmp_ge_u32 s89, 7
    s_cselect_b32 s25, 1, 0
    s_mul_i32 s7, s25, 7
    s_sub_u32 s26, s89, s7
    s_min_u32 s26, s26, 6
    s_lshr_b32 s7, s4, 1
    s_lshl_b32 s27, s26, 1
    s_add_u32 s27, s27, s7
    s_lshl_b32 s28, s88, 2
    s_lshl_b32 s7, s25, 1
    s_add_u32 s28, s28, s7
    s_and_b32 s7, s4, 1
    s_add_u32 s28, s28, s7
    s_mul_i32 s37, s4, 7168
    s_mul_i32 s36, s91, 200704
    s_add_u32 s36, s36, s37
    s_add_u32 s36, s36, 0x500000
    s_lshl_b32 s8, s26, 7
    s_mul_i32 s38, s4, 100352
    s_add_u32 s38, s38, s8
    s_mul_i32 s84, s4, 401408
    s_add_u32 s84, s84, s8
    s_mul_i32 s39, s4, 14336
    s_mul_i32 s85, s28, 28672
    s_lshl_b32 s8, s27, 6
    s_add_u32 s85, s85, s8
    s_cmp_lt_u32 s89, 14
    s_cselect_b32 s38, s38, 0x40000000
    s_cselect_b32 s84, s84, 0x40000000
    s_cselect_b32 s85, s85, 0x40000000
    s_lshr_b32 s7, s4, 1
    s_lshl_b32 s7, s7, 2
    s_and_b32 s8, s4, 1
    s_lshl_b32 s13, s5, 1
    s_add_u32 s13, s13, s8
    s_mul_i32 s80, s6, 7
    s_add_u32 s80, s80, s7
    s_mul_i32 s80, s80, 28
    s_add_u32 s80, s80, s13
    s_lshl_b32 s80, s80, 10
    s_add_u32 s80, s80, 0x500000
    s_mul_i32 s81, s6, 28
    s_add_u32 s81, s81, s13
    s_mul_i32 s81, s81, 896
    s_lshl_b32 s7, s7, 7
    s_add_u32 s81, s81, s7
    s_add_u32 s81, s81, 0x15a0000
    s_cmp_lt_u32 s5, 14
    s_cselect_b32 s80, s80, 0x40000000
    s_cselect_b32 s81, s81, 0x40000000
    s_cmp_lt_u32 s4, 2
    s_cselect_b32 s86, s80, 0x40000000
    s_cselect_b32 s87, s81, 0x40000000
    s_mul_i32 s15, s5, 114688
    s_mul_i32 s7, s6, 224
    s_add_u32 s15, s15, s7
    s_lshr_b32 s7, s4, 1
    s_mul_i32 s14, s7, 7296
    s_and_b32 s8, s4, 1
    s_mul_i32 s8, s8, 3072
    s_add_u32 s14, s14, s8
    v_bfe_u32 v7, v1, 2, 2
    v_lshl_add_u32 v7, v4, 2, v7
    v_mul_u32_u24 v219, 224, v7
    v_and_b32 v8, 3, v1
    v_lshl_add_u32 v219, v8, 3, v219
    v_bfe_u32 v8, v1, 4, 1
    v_mul_u32_u24 v8, 7296, v8
    v_add_u32 v219, v219, v8
    s_and_b32 s7, s4, 1
    s_mul_i32 s7, s7, 3584
    s_lshr_b32 s8, s4, 1
    s_lshl_b32 s8, s8, 7
    s_add_u32 s7, s7, s8
    s_add_u32 s7, s7, 24576
    v_add_u32 v219, s7, v219
    v_accvgpr_write_b32 a252, v219
    s_add_u32 s35, s24, 344960
    s_add_u32 m0, s11, 65536
    s_nop 0
    buffer_load_dwordx4 v218, s[44:47], s35 offen lds
    s_add_u32 s35, s23, 256
    s_add_u32 m0, s10, 49152
    s_nop 0
    buffer_load_dwordx4 v216, s[40:43], s35 offen lds
    s_add_u32 s35, s23, 7424
    s_add_u32 m0, s10, 50176
    s_nop 0
    buffer_load_dwordx4 v217, s[40:43], s35 offen lds
    s_add_u32 s35, s24, 345856
    s_add_u32 m0, s11, 69632
    s_nop 0
    buffer_load_dwordx4 v218, s[44:47], s35 offen lds
    s_add_u32 s35, s23, 14592
    s_add_u32 m0, s10, 51200
    s_nop 0
    buffer_load_dwordx4 v216, s[40:43], s35 offen lds
    s_add_u32 s35, s23, 21760
    s_add_u32 m0, s10, 52224
    s_nop 0
    buffer_load_dwordx4 v217, s[40:43], s35 offen lds
    s_waitcnt vmcnt(13)
    s_barrier
    ds_read_b128 v[16:19], v208 offset:0
    ds_read_b64_tr_b16 v[176:177], v212 offset:0
    ds_read_b64_tr_b16 v[178:179], v212 offset:256
    ds_read_b64_tr_b16 v[180:181], v212 offset:4096
    ds_read_b64_tr_b16 v[182:183], v212 offset:4352
    ds_read_b128 v[20:23], v209 offset:0
    ds_read_b64_tr_b16 a[64:65], v213 offset:0
    ds_read_b64_tr_b16 a[66:67], v213 offset:256
    ds_read_b64_tr_b16 a[68:69], v213 offset:4096
    ds_read_b64_tr_b16 a[70:71], v213 offset:4352
    ds_read_b128 v[24:27], v210 offset:0
    ds_read_b64_tr_b16 a[72:73], v214 offset:0
    ds_read_b64_tr_b16 a[74:75], v214 offset:256
    ds_read_b64_tr_b16 a[76:77], v214 offset:4096
    ds_read_b64_tr_b16 a[78:79], v214 offset:4352
    ds_read_b128 v[28:31], v211 offset:0
    ds_read_b64_tr_b16 a[80:81], v215 offset:0
    ds_read_b64_tr_b16 a[82:83], v215 offset:256
    ds_read_b64_tr_b16 a[84:85], v215 offset:4096
    ds_read_b64_tr_b16 a[86:87], v215 offset:4352
    s_waitcnt lgkmcnt(0)
    s_waitcnt vmcnt(6)
    s_barrier
    v_mfma_f32_32x32x16_bf16 v[128:143], v[176:179], v[16:19], 0
    ds_read_b128 v[32:35], v208 offset:24576
    ds_read_b64_tr_b16 v[184:185], v212 offset:24576
    ds_read_b64_tr_b16 v[186:187], v212 offset:24832
    v_mfma_f32_32x32x16_bf16 v[144:159], v[180:183], v[16:19], 0
    ds_read_b64_tr_b16 v[188:189], v212 offset:28672
    s_add_u32 s35, s24, 516992
    s_add_u32 m0, s11, 90112
    s_nop 0
    buffer_load_dwordx4 v218, s[44:47], s35 offen lds
    ds_read_b64_tr_b16 v[190:191], v212 offset:28928
    ds_read_b128 v[36:39], v209 offset:24576
    v_mfma_f32_32x32x16_bf16 v[128:143], a[64:67], v[20:23], v[128:143]
    s_add_u32 s35, s23, 384
    s_add_u32 m0, s10, 73728
    s_nop 0
    buffer_load_dwordx4 v216, s[40:43], s35 offen lds
    ds_read_b64_tr_b16 a[88:89], v213 offset:24576
    ds_read_b64_tr_b16 a[90:91], v213 offset:24832
    ds_read_b64_tr_b16 a[92:93], v213 offset:28672
    v_mfma_f32_32x32x16_bf16 v[144:159], a[68:71], v[20:23], v[144:159]
    s_add_u32 s35, s23, 7552
    s_add_u32 m0, s10, 74752
    s_nop 0
    buffer_load_dwordx4 v217, s[40:43], s35 offen lds
    ds_read_b64_tr_b16 a[94:95], v213 offset:28928
    ds_read_b128 v[40:43], v210 offset:24576
    ds_read_b64_tr_b16 a[96:97], v214 offset:24576
    v_mfma_f32_32x32x16_bf16 v[128:143], a[72:75], v[24:27], v[128:143]
    ds_read_b64_tr_b16 a[98:99], v214 offset:24832
    ds_read_b64_tr_b16 a[100:101], v214 offset:28672
    ds_read_b64_tr_b16 a[102:103], v214 offset:28928
    v_mfma_f32_32x32x16_bf16 v[144:159], a[76:79], v[24:27], v[144:159]
    s_add_u32 s35, s24, 517888
    s_add_u32 m0, s11, 94208
    s_nop 0
    buffer_load_dwordx4 v218, s[44:47], s35 offen lds
    ds_read_b128 v[44:47], v211 offset:24576
    ds_read_b64_tr_b16 a[104:105], v215 offset:24576
    ds_read_b64_tr_b16 a[106:107], v215 offset:24832
    v_mfma_f32_32x32x16_bf16 v[128:143], a[80:83], v[28:31], v[128:143]
    s_add_u32 s35, s23, 14720
    s_add_u32 m0, s10, 75776
    s_nop 0
    buffer_load_dwordx4 v216, s[40:43], s35 offen lds
    ds_read_b64_tr_b16 a[108:109], v215 offset:28672
    ds_read_b64_tr_b16 a[110:111], v215 offset:28928
    v_mfma_f32_32x32x16_bf16 v[144:159], a[84:87], v[28:31], v[144:159]
    s_add_u32 s35, s23, 21888
    s_add_u32 m0, s10, 76800
    s_nop 0
    buffer_load_dwordx4 v217, s[40:43], s35 offen lds
    v_dot2c_f32_bf16 v10, v16, v16
    v_dot2c_f32_bf16 v9, s17, v16
    v_dot2c_f32_bf16 v10, v17, v17
    v_dot2c_f32_bf16 v9, s17, v17
    v_dot2c_f32_bf16 v10, v18, v18
    v_dot2c_f32_bf16 v9, s17, v18
    v_dot2c_f32_bf16 v10, v19, v19
    v_dot2c_f32_bf16 v9, s17, v19
    v_dot2c_f32_bf16 v10, v20, v20
    v_dot2c_f32_bf16 v9, s17, v20
    v_dot2c_f32_bf16 v10, v21, v21
    v_dot2c_f32_bf16 v9, s17, v21
    v_dot2c_f32_bf16 v10, v22, v22
    v_dot2c_f32_bf16 v9, s17, v22
    v_dot2c_f32_bf16 v10, v23, v23
    v_dot2c_f32_bf16 v9, s17, v23
    v_dot2c_f32_bf16 v10, v24, v24
    v_dot2c_f32_bf16 v9, s17, v24
    v_dot2c_f32_bf16 v10, v25, v25
    v_dot2c_f32_bf16 v9, s17, v25
    v_dot2c_f32_bf16 v10, v26, v26
    v_dot2c_f32_bf16 v9, s17, v26
    v_dot2c_f32_bf16 v10, v27, v27
    v_dot2c_f32_bf16 v9, s17, v27
    v_dot2c_f32_bf16 v10, v28, v28
    v_dot2c_f32_bf16 v9, s17, v28
    v_dot2c_f32_bf16 v10, v29, v29
    v_dot2c_f32_bf16 v9, s17, v29
    v_dot2c_f32_bf16 v10, v30, v30
    v_dot2c_f32_bf16 v9, s17, v30
    v_dot2c_f32_bf16 v10, v31, v31
    v_dot2c_f32_bf16 v9, s17, v31
    v_dot2c_f32_bf16 v11, s17, v176
    v_dot2c_f32_bf16 v12, s17, v180
    v_dot2c_f32_bf16 v11, s17, v177
    v_dot2c_f32_bf16 v12, s17, v181
    v_dot2c_f32_bf16 v11, s17, v178
    v_dot2c_f32_bf16 v12, s17, v182
    v_dot2c_f32_bf16 v11, s17, v179
    v_dot2c_f32_bf16 v12, s17, v183
    s_waitcnt lgkmcnt(0)
    s_waitcnt vmcnt(6)
    s_barrier
    v_add_u32 v208, 49152, v208
    v_add_u32 v212, 49152, v212
    v_add_u32 v209, 49152, v209
    v_add_u32 v213, 49152, v213
    v_add_u32 v210, 49152, v210
    v_add_u32 v214, 49152, v214
    v_add_u32 v211, 49152, v211
    v_add_u32 v215, 49152, v215
    v_mfma_f32_32x32x16_bf16 v[128:143], v[184:187], v[32:35], v[128:143]
    ds_read_b128 v[48:51], v208 offset:0
    ds_read_b64_tr_b16 v[176:177], v212 offset:0
    ds_read_b64_tr_b16 v[178:179], v212 offset:256
    v_mfma_f32_32x32x16_bf16 v[144:159], v[188:191], v[32:35], v[144:159]
    ds_read_b64_tr_b16 v[180:181], v212 offset:4096
    s_add_u32 s35, s24, 689024
    s_add_u32 m0, s11, 114688
    s_nop 0
    buffer_load_dwordx4 v218, s[44:47], s35 offen lds
    ds_read_b64_tr_b16 v[182:183], v212 offset:4352
    ds_read_b128 v[52:55], v209 offset:0
    v_mfma_f32_32x32x16_bf16 v[128:143], a[88:91], v[36:39], v[128:143]
    s_add_u32 s35, s23, 512
    s_add_u32 m0, s10, 98304
    s_nop 0
    buffer_load_dwordx4 v216, s[40:43], s35 offen lds
    ds_read_b64_tr_b16 a[64:65], v213 offset:0
    ds_read_b64_tr_b16 a[66:67], v213 offset:256
    ds_read_b64_tr_b16 a[68:69], v213 offset:4096
    v_mfma_f32_32x32x16_bf16 v[144:159], a[92:95], v[36:39], v[144:159]
    s_add_u32 s35, s23, 7680
    s_add_u32 m0, s10, 99328
    s_nop 0
    buffer_load_dwordx4 v217, s[40:43], s35 offen lds
    ds_read_b64_tr_b16 a[70:71], v213 offset:4352
    ds_read_b128 v[56:59], v210 offset:0
    ds_read_b64_tr_b16 a[72:73], v214 offset:0
    v_mfma_f32_32x32x16_bf16 v[128:143], a[96:99], v[40:43], v[128:143]
    ds_read_b64_tr_b16 a[74:75], v214 offset:256
    ds_read_b64_tr_b16 a[76:77], v214 offset:4096
    ds_read_b64_tr_b16 a[78:79], v214 offset:4352
    v_mfma_f32_32x32x16_bf16 v[144:159], a[100:103], v[40:43], v[144:159]
    s_add_u32 s35, s24, 689920
    s_add_u32 m0, s11, 118784
    s_nop 0
    buffer_load_dwordx4 v218, s[44:47], s35 offen lds
    ds_read_b128 v[60:63], v211 offset:0
    ds_read_b64_tr_b16 a[80:81], v215 offset:0
    ds_read_b64_tr_b16 a[82:83], v215 offset:256
    v_mfma_f32_32x32x16_bf16 v[128:143], a[104:107], v[44:47], v[128:143]
    s_add_u32 s35, s23, 14848
    s_add_u32 m0, s10, 100352
    s_nop 0
    buffer_load_dwordx4 v216, s[40:43], s35 offen lds
    ds_read_b64_tr_b16 a[84:85], v215 offset:4096
    ds_read_b64_tr_b16 a[86:87], v215 offset:4352
    v_mfma_f32_32x32x16_bf16 v[144:159], a[108:111], v[44:47], v[144:159]
    s_add_u32 s35, s23, 22016
    s_add_u32 m0, s10, 101376
    s_nop 0
    buffer_load_dwordx4 v217, s[40:43], s35 offen lds
    v_dot2c_f32_bf16 v10, v32, v32
    v_dot2c_f32_bf16 v9, s17, v32
    v_dot2c_f32_bf16 v10, v33, v33
    v_dot2c_f32_bf16 v9, s17, v33
    v_dot2c_f32_bf16 v10, v34, v34
    v_dot2c_f32_bf16 v9, s17, v34
    v_dot2c_f32_bf16 v10, v35, v35
    v_dot2c_f32_bf16 v9, s17, v35
    v_dot2c_f32_bf16 v10, v36, v36
    v_dot2c_f32_bf16 v9, s17, v36
    v_dot2c_f32_bf16 v10, v37, v37
    v_dot2c_f32_bf16 v9, s17, v37
    v_dot2c_f32_bf16 v10, v38, v38
    v_dot2c_f32_bf16 v9, s17, v38
    v_dot2c_f32_bf16 v10, v39, v39
    v_dot2c_f32_bf16 v9, s17, v39
    v_dot2c_f32_bf16 v10, v40, v40
    v_dot2c_f32_bf16 v9, s17, v40
    v_dot2c_f32_bf16 v10, v41, v41
    v_dot2c_f32_bf16 v9, s17, v41
    v_dot2c_f32_bf16 v10, v42, v42
    v_dot2c_f32_bf16 v9, s17, v42
    v_dot2c_f32_bf16 v10, v43, v43
    v_dot2c_f32_bf16 v9, s17, v43
    v_dot2c_f32_bf16 v10, v44, v44
    v_dot2c_f32_bf16 v9, s17, v44
    v_dot2c_f32_bf16 v10, v45, v45
    v_dot2c_f32_bf16 v9, s17, v45
    v_dot2c_f32_bf16 v10, v46, v46
    v_dot2c_f32_bf16 v9, s17, v46
    v_dot2c_f32_bf16 v10, v47, v47
    v_dot2c_f32_bf16 v9, s17, v47
    v_dot2c_f32_bf16 v11, s17, v184
    v_dot2c_f32_bf16 v12, s17, v188
    v_dot2c_f32_bf16 v11, s17, v185
    v_dot2c_f32_bf16 v12, s17, v189
    v_dot2c_f32_bf16 v11, s17, v186
    v_dot2c_f32_bf16 v12, s17, v190
    v_dot2c_f32_bf16 v11, s17, v187
    v_dot2c_f32_bf16 v12, s17, v191
    s_waitcnt lgkmcnt(0)
    s_waitcnt vmcnt(6)
    s_barrier
    v_mfma_f32_32x32x16_bf16 v[128:143], v[176:179], v[48:51], v[128:143]
    ds_read_b128 v[64:67], v208 offset:24576
    ds_read_b64_tr_b16 v[184:185], v212 offset:24576
    ds_read_b64_tr_b16 v[186:187], v212 offset:24832
    v_mfma_f32_32x32x16_bf16 v[144:159], v[180:183], v[48:51], v[144:159]
    ds_read_b64_tr_b16 v[188:189], v212 offset:28672
    s_add_u32 s35, s24, 861056
    s_add_u32 m0, s11, 139264
    s_nop 0
    buffer_load_dwordx4 v218, s[44:47], s35 offen lds
    ds_read_b64_tr_b16 v[190:191], v212 offset:28928
    ds_read_b128 v[68:71], v209 offset:24576
    v_mfma_f32_32x32x16_bf16 v[128:143], a[64:67], v[52:55], v[128:143]
    s_add_u32 s35, s23, 640
    s_add_u32 m0, s10, 122880
    s_nop 0
    buffer_load_dwordx4 v216, s[40:43], s35 offen lds
    ds_read_b64_tr_b16 a[88:89], v213 offset:24576
    ds_read_b64_tr_b16 a[90:91], v213 offset:24832
    ds_read_b64_tr_b16 a[92:93], v213 offset:28672
    v_mfma_f32_32x32x16_bf16 v[144:159], a[68:71], v[52:55], v[144:159]
    s_add_u32 s35, s23, 7808
    s_add_u32 m0, s10, 123904
    s_nop 0
    buffer_load_dwordx4 v217, s[40:43], s35 offen lds
    ds_read_b64_tr_b16 a[94:95], v213 offset:28928
    ds_read_b128 v[72:75], v210 offset:24576
    ds_read_b64_tr_b16 a[96:97], v214 offset:24576
    v_mfma_f32_32x32x16_bf16 v[128:143], a[72:75], v[56:59], v[128:143]
    ds_read_b64_tr_b16 a[98:99], v214 offset:24832
    ds_read_b64_tr_b16 a[100:101], v214 offset:28672
    ds_read_b64_tr_b16 a[102:103], v214 offset:28928
    v_mfma_f32_32x32x16_bf16 v[144:159], a[76:79], v[56:59], v[144:159]
    s_add_u32 s35, s24, 861952
    s_add_u32 m0, s11, 143360
    s_nop 0
    buffer_load_dwordx4 v218, s[44:47], s35 offen lds
    ds_read_b128 v[76:79], v211 offset:24576
    ds_read_b64_tr_b16 a[104:105], v215 offset:24576
    ds_read_b64_tr_b16 a[106:107], v215 offset:24832
    v_mfma_f32_32x32x16_bf16 v[128:143], a[80:83], v[60:63], v[128:143]
    s_add_u32 s35, s23, 14976
    s_add_u32 m0, s10, 124928
    s_nop 0
    buffer_load_dwordx4 v216, s[40:43], s35 offen lds
    ds_read_b64_tr_b16 a[108:109], v215 offset:28672
    ds_read_b64_tr_b16 a[110:111], v215 offset:28928
    v_mfma_f32_32x32x16_bf16 v[144:159], a[84:87], v[60:63], v[144:159]
    s_add_u32 s35, s23, 22144
    s_add_u32 m0, s10, 125952
    s_nop 0
    buffer_load_dwordx4 v217, s[40:43], s35 offen lds
    v_dot2c_f32_bf16 v10, v48, v48
    v_dot2c_f32_bf16 v9, s17, v48
    v_dot2c_f32_bf16 v10, v49, v49
    v_dot2c_f32_bf16 v9, s17, v49
    v_dot2c_f32_bf16 v10, v50, v50
    v_dot2c_f32_bf16 v9, s17, v50
    v_dot2c_f32_bf16 v10, v51, v51
    v_dot2c_f32_bf16 v9, s17, v51
    v_dot2c_f32_bf16 v10, v52, v52
    v_dot2c_f32_bf16 v9, s17, v52
    v_dot2c_f32_bf16 v10, v53, v53
    v_dot2c_f32_bf16 v9, s17, v53
    v_dot2c_f32_bf16 v10, v54, v54
    v_dot2c_f32_bf16 v9, s17, v54
    v_dot2c_f32_bf16 v10, v55, v55
    v_dot2c_f32_bf16 v9, s17, v55
    v_dot2c_f32_bf16 v10, v56, v56
    v_dot2c_f32_bf16 v9, s17, v56
    v_dot2c_f32_bf16 v10, v57, v57
    v_dot2c_f32_bf16 v9, s17, v57
    v_dot2c_f32_bf16 v10, v58, v58
    v_dot2c_f32_bf16 v9, s17, v58
    v_dot2c_f32_bf16 v10, v59, v59
    v_dot2c_f32_bf16 v9, s17, v59
    v_dot2c_f32_bf16 v10, v60, v60
    v_dot2c_f32_bf16 v9, s17, v60
    v_dot2c_f32_bf16 v10, v61, v61
    v_dot2c_f32_bf16 v9, s17, v61
    v_dot2c_f32_bf16 v10, v62, v62
    v_dot2c_f32_bf16 v9, s17, v62
    v_dot2c_f32_bf16 v10, v63, v63
    v_dot2c_f32_bf16 v9, s17, v63
    v_dot2c_f32_bf16 v11, s17, v176
    v_dot2c_f32_bf16 v12, s17, v180
    v_dot2c_f32_bf16 v11, s17, v177
    v_dot2c_f32_bf16 v12, s17, v181
    v_dot2c_f32_bf16 v11, s17, v178
    v_dot2c_f32_bf16 v12, s17, v182
    v_dot2c_f32_bf16 v11, s17, v179
    v_dot2c_f32_bf16 v12, s17, v183
    s_waitcnt lgkmcnt(0)
    s_waitcnt vmcnt(6)
    s_barrier
    v_add_u32 v208, 49152, v208
    v_add_u32 v212, 49152, v212
    v_add_u32 v209, 49152, v209
    v_add_u32 v213, 49152, v213
    v_add_u32 v210, 49152, v210
    v_add_u32 v214, 49152, v214
    v_add_u32 v211, 49152, v211
    v_add_u32 v215, 49152, v215
    v_lshlrev_b32 v222, 2, v3
    buffer_load_dword a251, v222, s[68:71], 0 offen offset:0 sc1
    v_mfma_f32_32x32x16_bf16 v[128:143], v[184:187], v[64:67], v[128:143]
    ds_read_b128 v[80:83], v208 offset:0
    ds_read_b64_tr_b16 v[176:177], v212 offset:0
    ds_read_b64_tr_b16 v[178:179], v212 offset:256
    v_mfma_f32_32x32x16_bf16 v[144:159], v[188:191], v[64:67], v[144:159]
    s_add_u32 s35, s24, 1033088
    buffer_load_dwordx4 a[16:19], v218, s[44:47], s35 offen
    ds_read_b64_tr_b16 v[180:181], v212 offset:4096
    ds_read_b64_tr_b16 v[182:183], v212 offset:4352
    ds_read_b128 v[84:87], v209 offset:0
    v_mfma_f32_32x32x16_bf16 v[128:143], a[88:91], v[68:71], v[128:143]
    s_add_u32 s35, s23, 768
    buffer_load_dwordx4 a[0:3], v216, s[40:43], s35 offen
    ds_read_b64_tr_b16 a[64:65], v213 offset:0
    ds_read_b64_tr_b16 a[66:67], v213 offset:256
    ds_read_b64_tr_b16 a[68:69], v213 offset:4096
    v_mfma_f32_32x32x16_bf16 v[144:159], a[92:95], v[68:71], v[144:159]
    s_add_u32 s35, s23, 7936
    buffer_load_dwordx4 a[4:7], v217, s[40:43], s35 offen
    ds_read_b64_tr_b16 a[70:71], v213 offset:4352
    ds_read_b128 v[88:91], v210 offset:0
    ds_read_b64_tr_b16 a[72:73], v214 offset:0
    v_mfma_f32_32x32x16_bf16 v[128:143], a[96:99], v[72:75], v[128:143]
    ds_read_b64_tr_b16 a[74:75], v214 offset:256
    ds_read_b64_tr_b16 a[76:77], v214 offset:4096
    ds_read_b64_tr_b16 a[78:79], v214 offset:4352
    v_mfma_f32_32x32x16_bf16 v[144:159], a[100:103], v[72:75], v[144:159]
    s_add_u32 s35, s24, 1033984
    buffer_load_dwordx4 a[20:23], v218, s[44:47], s35 offen
    ds_read_b128 v[92:95], v211 offset:0
    ds_read_b64_tr_b16 a[80:81], v215 offset:0
    ds_read_b64_tr_b16 a[82:83], v215 offset:256
    v_mfma_f32_32x32x16_bf16 v[128:143], a[104:107], v[76:79], v[128:143]
    s_add_u32 s35, s23, 15104
    buffer_load_dwordx4 a[8:11], v216, s[40:43], s35 offen
    ds_read_b64_tr_b16 a[84:85], v215 offset:4096
    ds_read_b64_tr_b16 a[86:87], v215 offset:4352
    v_mfma_f32_32x32x16_bf16 v[144:159], a[108:111], v[76:79], v[144:159]
    s_add_u32 s35, s23, 22272
    buffer_load_dwordx4 a[12:15], v217, s[40:43], s35 offen
    v_dot2c_f32_bf16 v10, v64, v64
    v_dot2c_f32_bf16 v9, s17, v64
    v_dot2c_f32_bf16 v10, v65, v65
    v_dot2c_f32_bf16 v9, s17, v65
    v_dot2c_f32_bf16 v10, v66, v66
    v_dot2c_f32_bf16 v9, s17, v66
    v_dot2c_f32_bf16 v10, v67, v67
    v_dot2c_f32_bf16 v9, s17, v67
    v_dot2c_f32_bf16 v10, v68, v68
    v_dot2c_f32_bf16 v9, s17, v68
    v_dot2c_f32_bf16 v10, v69, v69
    v_dot2c_f32_bf16 v9, s17, v69
    v_dot2c_f32_bf16 v10, v70, v70
    v_dot2c_f32_bf16 v9, s17, v70
    v_dot2c_f32_bf16 v10, v71, v71
    v_dot2c_f32_bf16 v9, s17, v71
    v_dot2c_f32_bf16 v10, v72, v72
    v_dot2c_f32_bf16 v9, s17, v72
    v_dot2c_f32_bf16 v10, v73, v73
    v_dot2c_f32_bf16 v9, s17, v73
    v_dot2c_f32_bf16 v10, v74, v74
    v_dot2c_f32_bf16 v9, s17, v74
    v_dot2c_f32_bf16 v10, v75, v75
    v_dot2c_f32_bf16 v9, s17, v75
    v_dot2c_f32_bf16 v10, v76, v76
    v_dot2c_f32_bf16 v9, s17, v76
    v_dot2c_f32_bf16 v10, v77, v77
    v_dot2c_f32_bf16 v9, s17, v77
    v_dot2c_f32_bf16 v10, v78, v78
    v_dot2c_f32_bf16 v9, s17, v78
    v_dot2c_f32_bf16 v10, v79, v79
    v_dot2c_f32_bf16 v9, s17, v79
    v_dot2c_f32_bf16 v11, s17, v184
    v_dot2c_f32_bf16 v12, s17, v188
    v_dot2c_f32_bf16 v11, s17, v185
    v_dot2c_f32_bf16 v12, s17, v189
    v_dot2c_f32_bf16 v11, s17, v186
    v_dot2c_f32_bf16 v12, s17, v190
    v_dot2c_f32_bf16 v11, s17, v187
    v_dot2c_f32_bf16 v12, s17, v191
    s_waitcnt lgkmcnt(0)
    s_waitcnt vmcnt(7)
    s_barrier
    v_mfma_f32_32x32x16_bf16 v[128:143], v[176:179], v[80:83], v[128:143]
    ds_read_b128 v[96:99], v208 offset:24576
    ds_read_b64_tr_b16 v[184:185], v212 offset:24576
    ds_read_b64_tr_b16 v[186:187], v212 offset:24832
    v_mfma_f32_32x32x16_bf16 v[144:159], v[180:183], v[80:83], v[144:159]
    ds_read_b64_tr_b16 v[188:189], v212 offset:28672
    s_add_u32 s35, s24, 0
    buffer_load_dwordx4 a[24:27], v218, s[44:47], s35 offen
    ds_read_b64_tr_b16 v[190:191], v212 offset:28928
    ds_read_b128 v[100:103], v209 offset:24576
    v_mfma_f32_32x32x16_bf16 v[128:143], a[64:67], v[84:87], v[128:143]
    ds_read_b64_tr_b16 a[88:89], v213 offset:24576
    ds_read_b64_tr_b16 a[90:91], v213 offset:24832
    ds_read_b64_tr_b16 a[92:93], v213 offset:28672
    v_mfma_f32_32x32x16_bf16 v[144:159], a[68:71], v[84:87], v[144:159]
    s_add_u32 s35, s24, 172032
    buffer_load_dwordx4 a[28:31], v218, s[44:47], s35 offen
    ds_read_b64_tr_b16 a[94:95], v213 offset:28928
    ds_read_b128 v[104:107], v210 offset:24576
    ds_read_b64_tr_b16 a[96:97], v214 offset:24576
    v_mfma_f32_32x32x16_bf16 v[128:143], a[72:75], v[88:91], v[128:143]
    ds_read_b64_tr_b16 a[98:99], v214 offset:24832
    ds_read_b64_tr_b16 a[100:101], v214 offset:28672
    ds_read_b64_tr_b16 a[102:103], v214 offset:28928
    v_mfma_f32_32x32x16_bf16 v[144:159], a[76:79], v[88:91], v[144:159]
    s_add_u32 s35, s24, 344064
    buffer_load_dwordx4 a[32:35], v218, s[44:47], s35 offen
    ds_read_b128 v[108:111], v211 offset:24576
    ds_read_b64_tr_b16 a[104:105], v215 offset:24576
    ds_read_b64_tr_b16 a[106:107], v215 offset:24832
    v_mfma_f32_32x32x16_bf16 v[128:143], a[80:83], v[92:95], v[128:143]
    ds_read_b64_tr_b16 a[108:109], v215 offset:28672
    ds_read_b64_tr_b16 a[110:111], v215 offset:28928
    v_mfma_f32_32x32x16_bf16 v[144:159], a[84:87], v[92:95], v[144:159]
    s_add_u32 s35, s24, 516096
    buffer_load_dwordx4 a[36:39], v218, s[44:47], s35 offen
    v_add_u32 v219, s10, v2
    v_add_u32 v220, s11, v2
    s_waitcnt vmcnt(8)
    ds_write_b128 v219, a[0:3] offset:0
    s_waitcnt vmcnt(7)
    ds_write_b128 v219, a[4:7] offset:1024
    s_waitcnt vmcnt(5)
    ds_write_b128 v219, a[8:11] offset:2048
    s_waitcnt vmcnt(4)
    ds_write_b128 v219, a[12:15] offset:3072
    ds_write_b128 v220, a[16:19] offset:16384
    ds_write_b128 v220, a[20:23] offset:20480
    v_dot2c_f32_bf16 v10, v80, v80
    v_dot2c_f32_bf16 v9, s17, v80
    v_dot2c_f32_bf16 v10, v81, v81
    v_dot2c_f32_bf16 v9, s17, v81
    v_dot2c_f32_bf16 v10, v82, v82
    v_dot2c_f32_bf16 v9, s17, v82
    v_dot2c_f32_bf16 v10, v83, v83
    v_dot2c_f32_bf16 v9, s17, v83
    v_dot2c_f32_bf16 v10, v84, v84
    v_dot2c_f32_bf16 v9, s17, v84
    s_add_u32 s35, s24, 688128
    buffer_load_dwordx4 a[40:43], v218, s[44:47], s35 offen
    v_dot2c_f32_bf16 v10, v85, v85
    v_dot2c_f32_bf16 v9, s17, v85
    v_dot2c_f32_bf16 v10, v86, v86
    v_dot2c_f32_bf16 v9, s17, v86
    v_dot2c_f32_bf16 v10, v87, v87
    v_dot2c_f32_bf16 v9, s17, v87
    v_dot2c_f32_bf16 v10, v88, v88
    v_dot2c_f32_bf16 v9, s17, v88
    v_dot2c_f32_bf16 v10, v89, v89
    v_dot2c_f32_bf16 v9, s17, v89
    v_dot2c_f32_bf16 v10, v90, v90
    v_dot2c_f32_bf16 v9, s17, v90
    v_dot2c_f32_bf16 v10, v91, v91
    v_dot2c_f32_bf16 v9, s17, v91
    v_dot2c_f32_bf16 v10, v92, v92
    v_dot2c_f32_bf16 v9, s17, v92
    s_add_u32 s35, s24, 860160
    buffer_load_dwordx4 a[44:47], v218, s[44:47], s35 offen
    v_dot2c_f32_bf16 v10, v93, v93
    v_dot2c_f32_bf16 v9, s17, v93
    v_dot2c_f32_bf16 v10, v94, v94
    v_dot2c_f32_bf16 v9, s17, v94
    v_dot2c_f32_bf16 v10, v95, v95
    v_dot2c_f32_bf16 v9, s17, v95
    v_dot2c_f32_bf16 v11, s17, v176
    v_dot2c_f32_bf16 v12, s17, v180
    v_dot2c_f32_bf16 v11, s17, v177
    v_dot2c_f32_bf16 v12, s17, v181
    v_dot2c_f32_bf16 v11, s17, v178
    v_dot2c_f32_bf16 v12, s17, v182
    v_dot2c_f32_bf16 v11, s17, v179
    v_dot2c_f32_bf16 v12, s17, v183
    s_waitcnt lgkmcnt(0)
    s_barrier
    v_subrev_u32 v208, 98304, v208
    v_subrev_u32 v212, 98304, v212
    v_subrev_u32 v209, 98304, v209
    v_subrev_u32 v213, 98304, v213
    v_subrev_u32 v210, 98304, v210
    v_subrev_u32 v214, 98304, v214
    v_subrev_u32 v211, 98304, v211
    v_subrev_u32 v215, 98304, v215
    v_mfma_f32_32x32x16_bf16 v[128:143], v[184:187], v[96:99], v[128:143]
    ds_read_b128 v[112:115], v208 offset:0
    ds_read_b64_tr_b16 v[176:177], v212 offset:0
    s_add_u32 s35, s24, 1032192
    buffer_load_dwordx4 a[48:51], v218, s[44:47], s35 offen
    ds_read_b64_tr_b16 v[178:179], v212 offset:256
    v_mfma_f32_32x32x16_bf16 v[144:159], v[188:191], v[96:99], v[144:159]
    ds_read_b64_tr_b16 v[180:181], v212 offset:4096
    s_add_u32 m0, s14, 24576
    s_nop 0
    buffer_load_dwordx4 v248, s[56:59], s15 offen lds
    ds_read_b64_tr_b16 v[182:183], v212 offset:4352
    ds_read_b128 v[116:119], v209 offset:0
    v_mfma_f32_32x32x16_bf16 v[128:143], a[88:91], v[100:103], v[128:143]
    s_add_u32 m0, s14, 25600
    s_nop 0
    buffer_load_dwordx4 v249, s[56:59], s15 offen lds
    ds_read_b64_tr_b16 a[64:65], v213 offset:0
    ds_read_b64_tr_b16 a[66:67], v213 offset:256
    ds_read_b64_tr_b16 a[68:69], v213 offset:4096
    v_mfma_f32_32x32x16_bf16 v[144:159], a[92:95], v[100:103], v[144:159]
    s_add_u32 m0, s14, 26624
    s_nop 0
    buffer_load_dwordx4 v250, s[56:59], s15 offen lds
    ds_read_b64_tr_b16 a[70:71], v213 offset:4352
    ds_read_b128 v[120:123], v210 offset:0
    ds_read_b64_tr_b16 a[72:73], v214 offset:0
    v_mfma_f32_32x32x16_bf16 v[128:143], a[96:99], v[104:107], v[128:143]
    s_add_u32 m0, s14, 27648
    s_nop 0
    buffer_load_dwordx4 v251, s[56:59], s15 offen lds
    ds_read_b64_tr_b16 a[74:75], v214 offset:256
    ds_read_b64_tr_b16 a[76:77], v214 offset:4096
    ds_read_b64_tr_b16 a[78:79], v214 offset:4352
    v_mfma_f32_32x32x16_bf16 v[144:159], a[100:103], v[104:107], v[144:159]
    v_lshlrev_b32 v252, 7, v1
    s_mul_i32 s35, s98, 1664
    s_mov_b64 s[30:31], exec
    s_mov_b64 exec, 0x1fff
    buffer_load_dword a248, v252, s[60:63], s35 offen
    s_mov_b64 exec, s[30:31]
    ds_read_b128 v[124:127], v211 offset:0
    ds_read_b64_tr_b16 a[80:81], v215 offset:0
    ds_read_b64_tr_b16 a[82:83], v215 offset:256
    v_mfma_f32_32x32x16_bf16 v[128:143], a[104:107], v[108:111], v[128:143]
    v_lshlrev_b32 v252, 7, v1
    s_mul_i32 s35, s98, 512
    s_mov_b64 s[30:31], exec
    s_mov_b64 exec, 0xf
    buffer_load_dword a249, v252, s[52:55], s35 offen
    s_mov_b64 exec, s[30:31]
    ds_read_b64_tr_b16 a[84:85], v215 offset:4096
    ds_read_b64_tr_b16 a[86:87], v215 offset:4352
    v_mfma_f32_32x32x16_bf16 v[144:159], a[108:111], v[108:111], v[144:159]
    v_dot2c_f32_bf16 v10, v96, v96
    v_dot2c_f32_bf16 v9, s17, v96
    v_dot2c_f32_bf16 v10, v97, v97
    v_dot2c_f32_bf16 v9, s17, v97
    v_dot2c_f32_bf16 v10, v98, v98
    v_dot2c_f32_bf16 v9, s17, v98
    v_dot2c_f32_bf16 v10, v99, v99
    v_dot2c_f32_bf16 v9, s17, v99
    v_dot2c_f32_bf16 v10, v100, v100
    v_dot2c_f32_bf16 v9, s17, v100
    v_dot2c_f32_bf16 v10, v101, v101
    v_dot2c_f32_bf16 v9, s17, v101
    v_dot2c_f32_bf16 v10, v102, v102
    v_dot2c_f32_bf16 v9, s17, v102
    v_dot2c_f32_bf16 v10, v103, v103
    v_dot2c_f32_bf16 v9, s17, v103
    v_dot2c_f32_bf16 v10, v104, v104
    v_dot2c_f32_bf16 v9, s17, v104
    v_dot2c_f32_bf16 v10, v105, v105
    v_dot2c_f32_bf16 v9, s17, v105
    v_dot2c_f32_bf16 v10, v106, v106
    v_dot2c_f32_bf16 v9, s17, v106
    v_dot2c_f32_bf16 v10, v107, v107
    v_dot2c_f32_bf16 v9, s17, v107
    v_dot2c_f32_bf16 v10, v108, v108
    v_dot2c_f32_bf16 v9, s17, v108
    v_dot2c_f32_bf16 v10, v109, v109
    v_dot2c_f32_bf16 v9, s17, v109
    v_dot2c_f32_bf16 v10, v110, v110
    v_dot2c_f32_bf16 v9, s17, v110
    v_dot2c_f32_bf16 v10, v111, v111
    v_dot2c_f32_bf16 v9, s17, v111
    v_dot2c_f32_bf16 v11, s17, v184
    v_dot2c_f32_bf16 v12, s17, v188
    v_dot2c_f32_bf16 v11, s17, v185
    v_dot2c_f32_bf16 v12, s17, v189
    v_dot2c_f32_bf16 v11, s17, v186
    v_dot2c_f32_bf16 v12, s17, v190
    v_dot2c_f32_bf16 v11, s17, v187
    v_dot2c_f32_bf16 v12, s17, v191
    s_waitcnt lgkmcnt(0)
    v_dot2c_f32_bf16 v10, v112, v112
    v_dot2c_f32_bf16 v9, s17, v112
    v_dot2c_f32_bf16 v10, v113, v113
    v_dot2c_f32_bf16 v9, s17, v113
    v_dot2c_f32_bf16 v10, v114, v114
    v_dot2c_f32_bf16 v9, s17, v114
    v_dot2c_f32_bf16 v10, v115, v115
    v_dot2c_f32_bf16 v9, s17, v115
    v_dot2c_f32_bf16 v10, v116, v116
    v_dot2c_f32_bf16 v9, s17, v116
    v_dot2c_f32_bf16 v10, v117, v117
    v_dot2c_f32_bf16 v9, s17, v117
    v_dot2c_f32_bf16 v10, v118, v118
    v_dot2c_f32_bf16 v9, s17, v118
    v_dot2c_f32_bf16 v10, v119, v119
    v_dot2c_f32_bf16 v9, s17, v119
    v_dot2c_f32_bf16 v10, v120, v120
    v_dot2c_f32_bf16 v9, s17, v120
    v_dot2c_f32_bf16 v10, v121, v121
    v_dot2c_f32_bf16 v9, s17, v121
    v_dot2c_f32_bf16 v10, v122, v122
    v_dot2c_f32_bf16 v9, s17, v122
    v_dot2c_f32_bf16 v10, v123, v123
    v_dot2c_f32_bf16 v9, s17, v123
    v_dot2c_f32_bf16 v10, v124, v124
    v_dot2c_f32_bf16 v9, s17, v124
    v_dot2c_f32_bf16 v10, v125, v125
    v_dot2c_f32_bf16 v9, s17, v125
    v_dot2c_f32_bf16 v10, v126, v126
    v_dot2c_f32_bf16 v9, s17, v126
    v_dot2c_f32_bf16 v10, v127, v127
    v_dot2c_f32_bf16 v9, s17, v127
    v_mfma_f32_32x32x16_bf16 v[128:143], v[176:179], v[112:115], v[128:143]
    v_mfma_f32_32x32x16_bf16 v[144:159], v[180:183], v[112:115], v[144:159]
    v_mfma_f32_32x32x16_bf16 v[128:143], a[64:67], v[116:119], v[128:143]
    v_mfma_f32_32x32x16_bf16 v[144:159], a[68:71], v[116:119], v[144:159]
    v_mfma_f32_32x32x16_bf16 v[128:143], a[72:75], v[120:123], v[128:143]
    v_mfma_f32_32x32x16_bf16 v[144:159], a[76:79], v[120:123], v[144:159]
    v_mfma_f32_32x32x16_bf16 v[128:143], a[80:83], v[124:127], v[128:143]
    v_mfma_f32_32x32x16_bf16 v[144:159], a[84:87], v[124:127], v[144:159]
    v_mov_b32 v7, v9
    s_nop 1
    v_permlane32_swap_b32 v9, v7
    v_add_f32 v9, v9, v7
    v_mov_b32 v7, v10
    s_nop 1
    v_permlane32_swap_b32 v10, v7
    v_add_f32 v10, v10, v7
    v_dot2c_f32_bf16 v11, s17, v176
    v_dot2c_f32_bf16 v12, s17, v180
    v_dot2c_f32_bf16 v11, s17, v177
    v_dot2c_f32_bf16 v12, s17, v181
    v_dot2c_f32_bf16 v11, s17, v178
    v_dot2c_f32_bf16 v12, s17, v182
    v_dot2c_f32_bf16 v11, s17, v179
    v_dot2c_f32_bf16 v12, s17, v183
    s_lshl_b32 s7, s4, 3
    s_add_u32 s7, s7, 149504
    v_lshlrev_b32 v8, 5, v3
    v_add_u32 v8, s7, v8
    v_mov_b32 v7, v11
    s_nop 1
    v_permlane32_swap_b32 v11, v7
    v_add_f32 v11, v11, v7
    v_cvt_pk_bf16_f32 v224, v11, v11
    v_lshlrev_b32 v7, 16, v224
    v_sub_f32 v11, v11, v7
    v_cvt_pk_bf16_f32 v225, v11, v11
    v_lshlrev_b32 v7, 16, v225
    v_sub_f32 v11, v11, v7
    v_and_b32 v224, 0xffff, v224
    v_or_b32 v224, v224, v7
    v_cvt_pk_bf16_f32 v225, v11, v5
    ds_write_b64 v8, v[224:225] offset:0
    v_mov_b32 v7, v12
    s_nop 1
    v_permlane32_swap_b32 v12, v7
    v_add_f32 v12, v12, v7
    v_cvt_pk_bf16_f32 v224, v12, v12
    v_lshlrev_b32 v7, 16, v224
    v_sub_f32 v12, v12, v7
    v_cvt_pk_bf16_f32 v225, v12, v12
    v_lshlrev_b32 v7, 16, v225
    v_sub_f32 v12, v12, v7
    v_and_b32 v224, 0xffff, v224
    v_or_b32 v224, v224, v7
    v_cvt_pk_bf16_f32 v225, v12, v5
    ds_write_b64 v8, v[224:225] offset:1024
    s_waitcnt lgkmcnt(0)
    s_barrier
    v_lshlrev_b32 v11, 5, v3
    v_lshl_add_u32 v11, v4, 4, v11
    v_add_u32 v11, 149504, v11
    ds_read_b128 v[176:179], v11 offset:0
    ds_read_b128 v[180:183], v11 offset:1024
    v_bfe_u32 v7, v1, 2, 2
    v_lshl_add_u32 v7, v4, 2, v7
    v_mul_u32_u24 v12, 56, v7
    v_and_b32 v219, 3, v1
    v_bfe_u32 v220, v1, 4, 1
    v_lshl_add_u32 v219, v220, 2, v219
    v_lshl_add_u32 v12, v219, 3, v12
    v_add_u32 v12, 147456, v12
    ds_read_b64_tr_b16 v[232:233], v12 offset:0
    ds_read_b64_tr_b16 v[234:235], v12 offset:448
    ds_read_b64_tr_b16 v[236:237], v12 offset:896
    ds_read_b64_tr_b16 v[238:239], v12 offset:1344
    v_mul_f32 v15, 0x3b124925, v9
    v_mul_f32 v14, 0x3b124925, v10
    v_fma_f32 v14, -v15, v15, v14
    v_max_f32 v14, 0, v14
    v_cvt_pk_bf16_f32 v14, v14, v14
    v_lshlrev_b32 v14, 16, v14
    v_add_f32 v14, 0x3727c5ac, v14
    v_cvt_pk_bf16_f32 v14, v14, v14
    v_lshlrev_b32 v14, 16, v14
    v_sqrt_f32 v14, v14
    s_nop 0
    v_cvt_pk_bf16_f32 v14, v14, v14
    v_lshlrev_b32 v14, 16, v14
    v_rcp_f32 v226, v14
    v_sub_f32 v15, 0, v15
    v_cvt_pk_bf16_f32 v228, v15, v15
    v_mov_b32 v229, v228
    v_mov_b32 v230, v228
    v_mov_b32 v231, v228
    s_waitcnt lgkmcnt(5)
    s_nop 0
    v_mfma_f32_32x32x16_bf16 v[128:143], v[176:179], v[228:231], v[128:143]
    s_waitcnt lgkmcnt(4)
    v_mfma_f32_32x32x16_bf16 v[144:159], v[180:183], v[228:231], v[144:159]
    v_add_u32 v219, s11, v2
    v_add_u32 v219, 115200, v219
    s_waitcnt vmcnt(12)
    ds_write_b128 v219, a[24:27] offset:0
    s_waitcnt vmcnt(11)
    ds_write_b128 v219, a[28:31] offset:4096
    s_waitcnt vmcnt(10)
    ds_write_b128 v219, a[32:35] offset:8192
    s_waitcnt vmcnt(9)
    ds_write_b128 v219, a[36:39] offset:12288
    s_waitcnt vmcnt(8)
    ds_write_b128 v219, a[40:43] offset:16384
    s_waitcnt vmcnt(7)
    ds_write_b128 v219, a[44:47] offset:20480
    s_waitcnt vmcnt(6)
    ds_write_b128 v219, a[48:51] offset:24576
    s_lshl_b32 s7, s4, 5
    v_add_u32 v7, s7, v3
    v_mul_u32_u24 v219, 72, v7
    v_lshl_add_u32 v219, v4, 3, v219
    v_add_u32 v219, 103424, v219
    v_mul_u32_u24 v220, 136, v7
    v_lshl_add_u32 v220, v4, 3, v220
    v_add_u32 v220, 86016, v220
    v_pk_mul_f32 v[128:129], v[128:129], v[226:227] op_sel_hi:[1,0]
    v_pk_mul_f32 v[130:131], v[130:131], v[226:227] op_sel_hi:[1,0]
    v_pk_mul_f32 v[132:133], v[132:133], v[226:227] op_sel_hi:[1,0]
    v_pk_mul_f32 v[134:135], v[134:135], v[226:227] op_sel_hi:[1,0]
    v_pk_mul_f32 v[136:137], v[136:137], v[226:227] op_sel_hi:[1,0]
    v_pk_mul_f32 v[138:139], v[138:139], v[226:227] op_sel_hi:[1,0]
    v_pk_mul_f32 v[140:141], v[140:141], v[226:227] op_sel_hi:[1,0]
    v_pk_mul_f32 v[142:143], v[142:143], v[226:227] op_sel_hi:[1,0]
    v_cvt_pk_bf16_f32 v184, v128, v129
    v_cvt_pk_bf16_f32 v185, v130, v131
    v_cvt_pk_bf16_f32 v186, v132, v133
    v_cvt_pk_bf16_f32 v187, v134, v135
    v_cvt_pk_bf16_f32 v188, v136, v137
    v_cvt_pk_bf16_f32 v189, v138, v139
    v_cvt_pk_bf16_f32 v190, v140, v141
    s_add_u32 s35, s84, 0
    buffer_load_dwordx4 a[0:3], v221, s[60:63], s35 offen
    v_cvt_pk_bf16_f32 v191, v142, v143
    v_cndmask_b32 v190, 0, v190, s[32:33]
    v_cndmask_b32 v191, 0, v191, s[32:33]
    s_waitcnt lgkmcnt(9)
    v_mfma_f32_32x32x16_bf16 v[160:175], v[232:235], v[184:187], 0
    s_waitcnt lgkmcnt(7)
    v_mfma_f32_32x32x16_bf16 v[160:175], v[236:239], v[188:191], v[160:175]
    v_pk_mul_f32 v[144:145], v[144:145], v[226:227] op_sel_hi:[1,0]
    v_pk_mul_f32 v[146:147], v[146:147], v[226:227] op_sel_hi:[1,0]
    v_pk_mul_f32 v[148:149], v[148:149], v[226:227] op_sel_hi:[1,0]
    v_pk_mul_f32 v[150:151], v[150:151], v[226:227] op_sel_hi:[1,0]
    v_pk_mul_f32 v[152:153], v[152:153], v[226:227] op_sel_hi:[1,0]
    v_pk_mul_f32 v[154:155], v[154:155], v[226:227] op_sel_hi:[1,0]
    v_pk_mul_f32 v[156:157], v[156:157], v[226:227] op_sel_hi:[1,0]
    s_add_u32 s35, s84, 7168
    buffer_load_dwordx4 a[4:7], v221, s[60:63], s35 offen
    v_pk_mul_f32 v[158:159], v[158:159], v[226:227] op_sel_hi:[1,0]
    v_cvt_pk_bf16_f32 v192, v144, v145
    v_cvt_pk_bf16_f32 v193, v146, v147
    v_cvt_pk_bf16_f32 v194, v148, v149
    v_cvt_pk_bf16_f32 v195, v150, v151
    v_cvt_pk_bf16_f32 v196, v152, v153
    v_cvt_pk_bf16_f32 v197, v154, v155
    v_cvt_pk_bf16_f32 v198, v156, v157
    v_cvt_pk_bf16_f32 v199, v158, v159
    v_mov_b32 v7, 0x3f80
    v_cndmask_b32 v198, v7, v198, s[32:33]
    v_cndmask_b32 v199, 0, v199, s[32:33]
    ds_write_b64 v219, v[192:193] offset:0
    ds_write_b64 v219, v[194:195] offset:16
    ds_write_b64 v219, v[196:197] offset:32
    ds_write_b64 v219, v[198:199] offset:48
    v_cndmask_b32 v172, v160, v172, s[32:33]
    v_cndmask_b32 v173, v161, v173, s[32:33]
    v_cndmask_b32 v174, v162, v174, s[32:33]
    v_cndmask_b32 v175, v163, v175, s[32:33]
    v_max3_f32 v128, v160, v161, v162
    v_min3_f32 v130, v160, v161, v162
    s_add_u32 s35, s84, 14336
    buffer_load_dwordx4 a[8:11], v221, s[60:63], s35 offen
    v_max3_f32 v128, v128, v163, v164
    v_min3_f32 v130, v130, v163, v164
    v_max3_f32 v128, v128, v165, v166
    v_min3_f32 v130, v130, v165, v166
    v_max3_f32 v128, v128, v167, v168
    v_min3_f32 v130, v130, v167, v168
    v_max3_f32 v128, v128, v169, v170
    v_min3_f32 v130, v130, v169, v170
    v_max3_f32 v128, v128, v171, v172
    v_min3_f32 v130, v130, v171, v172
    v_max3_f32 v128, v128, v173, v174
    v_min3_f32 v130, v130, v173, v174
    v_max_f32 v128, v128, v175
    v_min_f32 v130, v130, v175
    v_mov_b32 v140, v128
    v_mov_b32 v141, v130
    s_nop 0
    v_permlane32_swap_b32 v128, v140
    v_permlane32_swap_b32 v130, v141
    v_max_f32 v128, v128, v140
    v_min_f32 v130, v130, v141
    v_mul_f32 v128, s16, v128
    s_add_u32 s35, s84, 21504
    buffer_load_dwordx4 a[12:15], v221, s[60:63], s35 offen
    v_mul_f32 v130, s16, v130
    v_pk_fma_f32 v[144:145], v[160:161], s[16:17], v[130:131] op_sel_hi:[1,0,0] neg_lo:[1,0,0] neg_hi:[1,0,0]
    v_pk_fma_f32 v[160:161], v[160:161], s[16:17], v[128:129] op_sel_hi:[1,0,0] neg_lo:[0,0,1] neg_hi:[0,0,1]
    v_pk_fma_f32 v[146:147], v[162:163], s[16:17], v[130:131] op_sel_hi:[1,0,0] neg_lo:[1,0,0] neg_hi:[1,0,0]
    v_pk_fma_f32 v[162:163], v[162:163], s[16:17], v[128:129] op_sel_hi:[1,0,0] neg_lo:[0,0,1] neg_hi:[0,0,1]
    v_pk_fma_f32 v[148:149], v[164:165], s[16:17], v[130:131] op_sel_hi:[1,0,0] neg_lo:[1,0,0] neg_hi:[1,0,0]
    v_pk_fma_f32 v[164:165], v[164:165], s[16:17], v[128:129] op_sel_hi:[1,0,0] neg_lo:[0,0,1] neg_hi:[0,0,1]
    v_pk_fma_f32 v[150:151], v[166:167], s[16:17], v[130:131] op_sel_hi:[1,0,0] neg_lo:[1,0,0] neg_hi:[1,0,0]
    v_pk_fma_f32 v[166:167], v[166:167], s[16:17], v[128:129] op_sel_hi:[1,0,0] neg_lo:[0,0,1] neg_hi:[0,0,1]
    v_pk_fma_f32 v[152:153], v[168:169], s[16:17], v[130:131] op_sel_hi:[1,0,0] neg_lo:[1,0,0] neg_hi:[1,0,0]
    v_pk_fma_f32 v[168:169], v[168:169], s[16:17], v[128:129] op_sel_hi:[1,0,0] neg_lo:[0,0,1] neg_hi:[0,0,1]
    v_pk_fma_f32 v[154:155], v[170:171], s[16:17], v[130:131] op_sel_hi:[1,0,0] neg_lo:[1,0,0] neg_hi:[1,0,0]
    v_pk_fma_f32 v[170:171], v[170:171], s[16:17], v[128:129] op_sel_hi:[1,0,0] neg_lo:[0,0,1] neg_hi:[0,0,1]
    v_pk_fma_f32 v[156:157], v[172:173], s[16:17], v[130:131] op_sel_hi:[1,0,0] neg_lo:[1,0,0] neg_hi:[1,0,0]
    v_pk_fma_f32 v[172:173], v[172:173], s[16:17], v[128:129] op_sel_hi:[1,0,0] neg_lo:[0,0,1] neg_hi:[0,0,1]
    v_pk_fma_f32 v[158:159], v[174:175], s[16:17], v[130:131] op_sel_hi:[1,0,0] neg_lo:[1,0,0] neg_hi:[1,0,0]
    v_pk_fma_f32 v[174:175], v[174:175], s[16:17], v[128:129] op_sel_hi:[1,0,0] neg_lo:[0,0,1] neg_hi:[0,0,1]
    v_exp_f32 v144, v144
    v_exp_f32 v160, v160
    v_exp_f32 v145, v145
    s_add_u32 s35, s84, 28672
    buffer_load_dwordx4 a[16:19], v221, s[60:63], s35 offen
    v_exp_f32 v161, v161
    v_exp_f32 v146, v146
    v_exp_f32 v162, v162
    v_exp_f32 v147, v147
    v_exp_f32 v163, v163
    v_exp_f32 v148, v148
    v_exp_f32 v164, v164
    v_exp_f32 v149, v149
    v_exp_f32 v165, v165
    v_exp_f32 v150, v150
    v_exp_f32 v166, v166
    v_exp_f32 v151, v151
    v_exp_f32 v167, v167
    v_exp_f32 v152, v152
    s_add_u32 s35, s84, 35840
    buffer_load_dwordx4 a[20:23], v221, s[60:63], s35 offen
    v_exp_f32 v168, v168
    v_exp_f32 v153, v153
    v_exp_f32 v169, v169
    v_exp_f32 v154, v154
    v_exp_f32 v170, v170
    v_exp_f32 v155, v155
    v_exp_f32 v171, v171
    v_exp_f32 v156, v156
    v_exp_f32 v172, v172
    v_exp_f32 v157, v157
    v_exp_f32 v173, v173
    v_exp_f32 v158, v158
    v_exp_f32 v174, v174
    v_exp_f32 v159, v159
    s_add_u32 s35, s84, 43008
    buffer_load_dwordx4 a[24:27], v221, s[60:63], s35 offen
    v_exp_f32 v175, v175
    v_pk_add_f32 v[132:133], v[160:161], v[162:163]
    v_pk_add_f32 v[134:135], v[144:145], v[146:147]
    v_pk_add_f32 v[132:133], v[132:133], v[164:165]
    v_pk_add_f32 v[134:135], v[134:135], v[148:149]
    v_pk_add_f32 v[132:133], v[132:133], v[166:167]
    v_pk_add_f32 v[134:135], v[134:135], v[150:151]
    v_pk_add_f32 v[132:133], v[132:133], v[168:169]
    v_pk_add_f32 v[134:135], v[134:135], v[152:153]
    v_pk_add_f32 v[132:133], v[132:133], v[170:171]
    v_pk_add_f32 v[134:135], v[134:135], v[154:155]
    v_pk_add_f32 v[136:137], v[172:173], v[174:175]
    v_pk_add_f32 v[138:139], v[156:157], v[158:159]
    v_pk_fma_f32 v[132:133], v[136:137], v[6:7], v[132:133] op_sel_hi:[1,0,1]
    v_pk_fma_f32 v[134:135], v[138:139], v[6:7], v[134:135] op_sel_hi:[1,0,1]
    v_add_f32 v132, v132, v133
    v_add_f32 v134, v134, v135
    v_mov_b32 v140, v132
    v_mov_b32 v141, v134
    s_nop 0
    v_permlane32_swap_b32 v132, v140
    s_add_u32 s35, s84, 50176
    buffer_load_dwordx4 a[28:31], v221, s[60:63], s35 offen
    v_permlane32_swap_b32 v134, v141
    v_add_f32 v132, v132, v140
    v_add_f32 v134, v134, v141
    v_rcp_f32 v132, v132
    v_rcp_f32 v134, v134
    v_mul_f32 v136, v132, v6
    v_mul_f32 v138, v134, v6
    v_pk_mul_f32 v[160:161], v[160:161], v[132:133] op_sel_hi:[1,0]
    v_pk_mul_f32 v[144:145], v[144:145], v[134:135] op_sel_hi:[1,0]
    v_pk_mul_f32 v[162:163], v[162:163], v[132:133] op_sel_hi:[1,0]
    v_pk_mul_f32 v[146:147], v[146:147], v[134:135] op_sel_hi:[1,0]
    v_pk_mul_f32 v[164:165], v[164:165], v[132:133] op_sel_hi:[1,0]
    v_pk_mul_f32 v[148:149], v[148:149], v[134:135] op_sel_hi:[1,0]
    v_pk_mul_f32 v[166:167], v[166:167], v[132:133] op_sel_hi:[1,0]
    v_pk_mul_f32 v[150:151], v[150:151], v[134:135] op_sel_hi:[1,0]
    v_pk_mul_f32 v[168:169], v[168:169], v[132:133] op_sel_hi:[1,0]
    v_pk_mul_f32 v[152:153], v[152:153], v[134:135] op_sel_hi:[1,0]
    v_pk_mul_f32 v[170:171], v[170:171], v[132:133] op_sel_hi:[1,0]
    v_pk_mul_f32 v[154:155], v[154:155], v[134:135] op_sel_hi:[1,0]
    v_pk_mul_f32 v[172:173], v[172:173], v[136:137] op_sel_hi:[1,0]
    v_pk_mul_f32 v[156:157], v[156:157], v[138:139] op_sel_hi:[1,0]
    v_pk_mul_f32 v[174:175], v[174:175], v[136:137] op_sel_hi:[1,0]
    v_pk_mul_f32 v[158:159], v[158:159], v[138:139] op_sel_hi:[1,0]
    v_cvt_pk_bf16_f32 v240, v160, v161
    v_cvt_pk_bf16_f32 v248, v144, v145
    v_cvt_pk_bf16_f32 v241, v162, v163
    v_cvt_pk_bf16_f32 v249, v146, v147
    v_cvt_pk_bf16_f32 v242, v164, v165
    v_cvt_pk_bf16_f32 v250, v148, v149
    v_cvt_pk_bf16_f32 v243, v166, v167
    v_cvt_pk_bf16_f32 v251, v150, v151
    v_cvt_pk_bf16_f32 v244, v168, v169
    v_cvt_pk_bf16_f32 v252, v152, v153
    v_cvt_pk_bf16_f32 v245, v170, v171
    v_cvt_pk_bf16_f32 v253, v154, v155
    v_cvt_pk_bf16_f32 v246, v172, v173
    v_cvt_pk_bf16_f32 v254, v156, v157
    v_cvt_pk_bf16_f32 v247, v174, v175
    v_cvt_pk_bf16_f32 v255, v158, v159
    ds_write_b64 v220, v[240:241] offset:0
    ds_write_b64 v220, v[242:243] offset:16
    ds_write_b64 v220, v[244:245] offset:32
    ds_write_b64 v220, v[246:247] offset:48
    ds_write_b64 v220, v[248:249] offset:64
    ds_write_b64 v220, v[250:251] offset:80
    ds_write_b64 v220, v[252:253] offset:96
    ds_write_b64 v220, v[254:255] offset:112
    v_lshrrev_b32 v7, 4, v1
    v_bfe_u32 v219, v1, 2, 2
    v_lshl_add_u32 v7, v7, 3, v219
    v_and_b32 v8, 3, v1
    v_mul_u32_u24 v219, 136, v7
    v_lshl_add_u32 v219, v8, 3, v219
    s_lshl_b32 s7, s4, 5
    s_add_u32 s7, s7, 86016
    v_add_u32 v219, s7, v219
    v_mul_u32_u24 v220, 72, v7
    v_lshl_add_u32 v220, v8, 3, v220
    v_add_u32 v220, 103424, v220
    s_waitcnt vmcnt(10)
    s_waitcnt lgkmcnt(0)
    s_barrier
    ds_read_b64_tr_b16 v[128:129], v219 offset:0
    ds_read_b64_tr_b16 v[130:131], v219 offset:544
    ds_read_b64_tr_b16 v[176:177], v220 offset:0
    ds_read_b64_tr_b16 v[178:179], v220 offset:288
    ds_read_b64_tr_b16 v[192:193], v220 offset:32
    ds_read_b64_tr_b16 v[194:195], v220 offset:320
    ds_read_b64_tr_b16 v[132:133], v219 offset:4352
    ds_read_b64_tr_b16 v[134:135], v219 offset:4896
    ds_read_b64_tr_b16 v[180:181], v220 offset:2304
    ds_read_b64_tr_b16 v[182:183], v220 offset:2592
    ds_read_b64_tr_b16 v[196:197], v220 offset:2336
    ds_read_b64_tr_b16 v[198:199], v220 offset:2624
    ds_read_b64_tr_b16 v[136:137], v219 offset:8704
    ds_read_b64_tr_b16 v[138:139], v219 offset:9248
    ds_read_b64_tr_b16 v[184:185], v220 offset:4608
    ds_read_b64_tr_b16 v[186:187], v220 offset:4896
    ds_read_b64_tr_b16 v[200:201], v220 offset:4640
    ds_read_b64_tr_b16 v[202:203], v220 offset:4928
    ds_read_b64_tr_b16 v[140:141], v219 offset:13056
    ds_read_b64_tr_b16 v[142:143], v219 offset:13600
    ds_read_b64_tr_b16 v[188:189], v220 offset:6912
    ds_read_b64_tr_b16 v[190:191], v220 offset:7200
    ds_read_b64_tr_b16 v[204:205], v220 offset:6944
    ds_read_b64_tr_b16 v[206:207], v220 offset:7232
    v_accvgpr_read_b32 v8, a252
    ds_read_b64_tr_b16 v[240:241], v8 offset:0
    ds_read_b64_tr_b16 v[242:243], v8 offset:1792
    ds_read_b64_tr_b16 v[244:245], v8 offset:32
    ds_read_b64_tr_b16 v[246:247], v8 offset:1824
    ds_read_b64_tr_b16 v[248:249], v8 offset:64
    ds_read_b64_tr_b16 v[250:251], v8 offset:1856
    ds_read_b64_tr_b16 v[252:253], v8 offset:96
    ds_read_b64_tr_b16 v[254:255], v8 offset:1888
    v_and_b32 v219, 15, v1
    v_bfe_u32 v7, v1, 4, 1
    v_lshl_add_u32 v219, v7, 5, v219
    v_lshlrev_b32 v219, 4, v219
    v_lshl_add_u32 v219, v4, 3, v219
    s_lshl_b32 s9, s6, 4
    s_add_u32 s9, s9, s5
    s_lshl_b32 s9, s9, 12
    s_add_u32 s9, s9, s11
    s_add_u32 s9, s9, 0xf00000
    v_add_u32 v212, 98816, v212
    v_add_u32 v213, 98816, v213
    v_add_u32 v214, 98816, v214
    v_add_u32 v215, 98816, v215
    s_waitcnt lgkmcnt(15)
    v_mfma_f32_16x16x32_bf16 v[144:147], v[128:131], v[176:179], 0
    v_mfma_f32_16x16x32_bf16 v[148:151], v[128:131], v[192:195], 0
    v_mfma_f32_16x16x32_bf16 v[144:147], v[132:135], v[180:183], v[144:147]
    v_mfma_f32_16x16x32_bf16 v[148:151], v[132:135], v[196:199], v[148:151]
    v_mfma_f32_16x16x32_bf16 v[144:147], v[136:139], v[184:187], v[144:147]
    s_waitcnt lgkmcnt(14)
    v_mfma_f32_16x16x32_bf16 v[148:151], v[136:139], v[200:203], v[148:151]
    s_waitcnt lgkmcnt(10)
    v_mfma_f32_16x16x32_bf16 v[144:147], v[140:143], v[188:191], v[144:147]
    s_waitcnt lgkmcnt(8)
    v_mfma_f32_16x16x32_bf16 v[148:151], v[140:143], v[204:207], v[148:151]
    s_nop 5
    v_cvt_pk_bf16_f32 v128, v144, v145
    v_cvt_pk_bf16_f32 v129, v146, v147
    buffer_store_dwordx2 v[128:129], v219, s[72:75], s9 offen offset:0 sc1
    v_cvt_pk_bf16_f32 v130, v148, v149
    v_cvt_pk_bf16_f32 v131, v150, v151
    buffer_store_dwordx2 v[130:131], v219, s[72:75], s9 offen offset:256 sc1
    s_add_u32 s9, s80, 0
    s_waitcnt lgkmcnt(6)
    buffer_store_dwordx4 v[240:243], v2, s[72:75], s9 offen sc1
    s_add_u32 s9, s80, 28672
    s_waitcnt lgkmcnt(4)
    buffer_store_dwordx4 v[244:247], v2, s[72:75], s9 offen sc1
    s_add_u32 s9, s80, 57344
    s_waitcnt lgkmcnt(2)
    buffer_store_dwordx4 v[248:251], v2, s[72:75], s9 offen sc1
    s_add_u32 s9, s86, 86016
    s_waitcnt lgkmcnt(0)
    buffer_store_dwordx4 v[252:255], v2, s[72:75], s9 offen sc1
    v_mov_b32 v160, 0
    v_mov_b32 v161, 0
    v_mov_b32 v162, 0
    v_mov_b32 v163, 0
    v_dot2c_f32_bf16 v160, s17, v240
    v_dot2c_f32_bf16 v161, s17, v244
    v_dot2c_f32_bf16 v162, s17, v248
    v_dot2c_f32_bf16 v163, s17, v252
    v_dot2c_f32_bf16 v160, s17, v241
    v_dot2c_f32_bf16 v161, s17, v245
    v_dot2c_f32_bf16 v162, s17, v249
    v_dot2c_f32_bf16 v163, s17, v253
    v_dot2c_f32_bf16 v160, s17, v242
    v_dot2c_f32_bf16 v161, s17, v246
    v_dot2c_f32_bf16 v162, s17, v250
    v_dot2c_f32_bf16 v163, s17, v254
    v_dot2c_f32_bf16 v160, s17, v243
    v_dot2c_f32_bf16 v161, s17, v247
    v_dot2c_f32_bf16 v162, s17, v251
    v_dot2c_f32_bf16 v163, s17, v255
    v_mov_b32 v164, v160
    v_mov_b32 v165, v161
    v_mov_b32 v166, v162
    v_mov_b32 v167, v163
    v_permlane32_swap_b32 v160, v164
    v_permlane32_swap_b32 v161, v165
    v_permlane32_swap_b32 v162, v166
    v_permlane32_swap_b32 v163, v167
    v_add_f32 v160, v160, v164
    v_add_f32 v161, v161, v165
    v_add_f32 v162, v162, v166
    v_add_f32 v163, v163, v167
    v_lshlrev_b32 v7, 2, v3
    v_mov_b32 v8, 0x40000000
    v_cndmask_b32 v7, v8, v7, s[32:33]
    buffer_store_dword v160, v7, s[72:75], s81 offen offset:0 sc1
    buffer_store_dword v161, v7, s[72:75], s81 offen offset:128 sc1
    buffer_store_dword v162, v7, s[72:75], s81 offen offset:256 sc1
    buffer_store_dword v163, v7, s[72:75], s87 offen offset:384 sc1
    ds_read_b64_tr_b16 v[132:133], v212 offset:0
    ds_read_b64_tr_b16 v[134:135], v212 offset:256
    ds_read_b64_tr_b16 v[180:181], v213 offset:0
    ds_read_b64_tr_b16 v[182:183], v213 offset:256
    ds_read_b64_tr_b16 v[184:185], v214 offset:0
    ds_read_b64_tr_b16 v[186:187], v214 offset:256
    ds_read_b64_tr_b16 v[188:189], v215 offset:0
    ds_read_b64_tr_b16 v[190:191], v215 offset:256
    ds_read_b64_tr_b16 v[136:137], v212 offset:4096
    ds_read_b64_tr_b16 v[138:139], v212 offset:4352
    ds_read_b64_tr_b16 v[196:197], v213 offset:4096
    ds_read_b64_tr_b16 v[198:199], v213 offset:4352
    ds_read_b64_tr_b16 v[200:201], v214 offset:4096
    ds_read_b64_tr_b16 v[202:203], v214 offset:4352
    ds_read_b64_tr_b16 v[204:205], v215 offset:4096
    ds_read_b64_tr_b16 v[206:207], v215 offset:4352
    s_waitcnt lgkmcnt(14)
    v_mfma_f32_32x32x16_bf16 v[160:175], v[132:135], v[16:19], 0
    s_add_u32 s35, s84, 57344
    buffer_load_dwordx4 a[32:35], v221, s[60:63], s35 offen
    ds_read_b64_tr_b16 v[140:141], v212 offset:8192
    ds_read_b64_tr_b16 v[142:143], v212 offset:8448
    s_waitcnt lgkmcnt(14)
    v_mfma_f32_32x32x16_bf16 v[160:175], v[180:183], v[20:23], v[160:175]
    ds_read_b64_tr_b16 v[180:181], v213 offset:8192
    ds_read_b64_tr_b16 v[182:183], v213 offset:8448
    s_waitcnt lgkmcnt(14)
    v_mfma_f32_32x32x16_bf16 v[160:175], v[184:187], v[24:27], v[160:175]
    ds_read_b64_tr_b16 v[184:185], v214 offset:8192
    s_add_u32 s35, s84, 64512
    buffer_load_dwordx4 a[36:39], v221, s[60:63], s35 offen
    ds_read_b64_tr_b16 v[186:187], v214 offset:8448
    s_waitcnt lgkmcnt(14)
    v_mfma_f32_32x32x16_bf16 v[160:175], v[188:191], v[28:31], v[160:175]
    ds_read_b64_tr_b16 v[188:189], v215 offset:8192
    ds_read_b64_tr_b16 v[190:191], v215 offset:8448
    s_waitcnt lgkmcnt(14)
    v_mfma_f32_32x32x16_bf16 v[160:175], v[136:139], v[32:35], v[160:175]
    ds_read_b64_tr_b16 v[144:145], v212 offset:12288
    ds_read_b64_tr_b16 v[146:147], v212 offset:12544
    s_waitcnt lgkmcnt(14)
    v_mfma_f32_32x32x16_bf16 v[160:175], v[196:199], v[36:39], v[160:175]
    s_add_u32 s35, s84, 71680
    buffer_load_dwordx4 a[40:43], v221, s[60:63], s35 offen
    ds_read_b64_tr_b16 v[196:197], v213 offset:12288
    ds_read_b64_tr_b16 v[198:199], v213 offset:12544
    s_waitcnt lgkmcnt(14)
    v_mfma_f32_32x32x16_bf16 v[160:175], v[200:203], v[40:43], v[160:175]
    ds_read_b64_tr_b16 v[200:201], v214 offset:12288
    ds_read_b64_tr_b16 v[202:203], v214 offset:12544
    s_waitcnt lgkmcnt(14)
    v_mfma_f32_32x32x16_bf16 v[160:175], v[204:207], v[44:47], v[160:175]
    s_add_u32 s35, s84, 78848
    buffer_load_dwordx4 a[44:47], v221, s[60:63], s35 offen
    ds_read_b64_tr_b16 v[204:205], v215 offset:12288
    ds_read_b64_tr_b16 v[206:207], v215 offset:12544
    s_waitcnt lgkmcnt(14)
    v_mfma_f32_32x32x16_bf16 v[160:175], v[140:143], v[48:51], v[160:175]
    ds_read_b64_tr_b16 v[148:149], v212 offset:16384
    ds_read_b64_tr_b16 v[150:151], v212 offset:16640
    s_waitcnt lgkmcnt(14)
    v_mfma_f32_32x32x16_bf16 v[160:175], v[180:183], v[52:55], v[160:175]
    s_add_u32 s35, s84, 86016
    buffer_load_dwordx4 a[48:51], v221, s[60:63], s35 offen
    ds_read_b64_tr_b16 v[180:181], v213 offset:16384
    ds_read_b64_tr_b16 v[182:183], v213 offset:16640
    s_waitcnt lgkmcnt(14)
    v_mfma_f32_32x32x16_bf16 v[160:175], v[184:187], v[56:59], v[160:175]
    ds_read_b64_tr_b16 v[184:185], v214 offset:16384
    ds_read_b64_tr_b16 v[186:187], v214 offset:16640
    s_waitcnt lgkmcnt(14)
    v_mfma_f32_32x32x16_bf16 v[160:175], v[188:191], v[60:63], v[160:175]
    ds_read_b64_tr_b16 v[188:189], v215 offset:16384
    s_add_u32 s35, s84, 93184
    buffer_load_dwordx4 a[52:55], v221, s[60:63], s35 offen
    ds_read_b64_tr_b16 v[190:191], v215 offset:16640
    s_waitcnt lgkmcnt(14)
    v_mfma_f32_32x32x16_bf16 v[160:175], v[144:147], v[64:67], v[160:175]
    ds_read_b64_tr_b16 v[152:153], v212 offset:20480
    ds_read_b64_tr_b16 v[154:155], v212 offset:20736
    s_waitcnt lgkmcnt(14)
    v_mfma_f32_32x32x16_bf16 v[160:175], v[196:199], v[68:71], v[160:175]
    ds_read_b64_tr_b16 v[196:197], v213 offset:20480
    ds_read_b64_tr_b16 v[198:199], v213 offset:20736
    s_waitcnt lgkmcnt(14)
    v_mfma_f32_32x32x16_bf16 v[160:175], v[200:203], v[72:75], v[160:175]
    ds_read_b64_tr_b16 v[200:201], v214 offset:20480
    ds_read_b64_tr_b16 v[202:203], v214 offset:20736
    s_waitcnt lgkmcnt(14)
    v_mfma_f32_32x32x16_bf16 v[160:175], v[204:207], v[76:79], v[160:175]
    ds_read_b64_tr_b16 v[204:205], v215 offset:20480
    ds_read_b64_tr_b16 v[206:207], v215 offset:20736
    s_waitcnt vmcnt(6)
    s_barrier
    v_accvgpr_read_b32 v7, a251
    s_cmp_lg_u32 s4, 0
    s_cbranch_scc1 L_sequential_preLN__linear_kernel_hedgehog__glu_gated_geglu__prompt_kernel_7
    v_cmp_ne_u32 vcc, 1, v7
    s_nop 0
    s_cmp_eq_u64 vcc, 0
    s_cbranch_scc1 L_sequential_preLN__linear_kernel_hedgehog__glu_gated_geglu__prompt_kernel_7
    s_mov_b32 s34, 0
L_sequential_preLN__linear_kernel_hedgehog__glu_gated_geglu__prompt_kernel_8:
    buffer_load_dword v7, v222, s[68:71], 0 offen offset:0 sc1
    s_waitcnt vmcnt(0)
    v_cmp_ne_u32 vcc, 1, v7
    s_nop 0
    s_cmp_eq_u64 vcc, 0
    s_cbranch_scc1 L_sequential_preLN__linear_kernel_hedgehog__glu_gated_geglu__prompt_kernel_9
    s_sleep 1
    s_add_u32 s34, s34, 1
    s_cmp_lt_u32 s34, 4194304
    s_cbranch_scc1 L_sequential_preLN__linear_kernel_hedgehog__glu_gated_geglu__prompt_kernel_8
L_sequential_preLN__linear_kernel_hedgehog__glu_gated_geglu__prompt_kernel_9:
L_sequential_preLN__linear_kernel_hedgehog__glu_gated_geglu__prompt_kernel_7:
    s_cmp_lg_u32 s4, 0
    s_cbranch_scc1 L_sequential_preLN__linear_kernel_hedgehog__glu_gated_geglu__prompt_kernel_10
    s_mov_b64 s[30:31], exec
    s_mov_b64 exec, 1
    v_mov_b32 v7, 1
    buffer_atomic_add v7, off, s[72:75], s21 offset:0 sc1
    s_mov_b64 exec, s[30:31]
L_sequential_preLN__linear_kernel_hedgehog__glu_gated_geglu__prompt_kernel_10:
    s_waitcnt lgkmcnt(14)
    v_mfma_f32_32x32x16_bf16 v[160:175], v[148:151], v[80:83], v[160:175]
    ds_read_b64_tr_b16 v[156:157], v212 offset:24576
    ds_read_b64_tr_b16 v[158:159], v212 offset:24832
    s_waitcnt lgkmcnt(14)
    v_mfma_f32_32x32x16_bf16 v[160:175], v[180:183], v[84:87], v[160:175]
    ds_read_b64_tr_b16 v[180:181], v213 offset:24576
    ds_read_b64_tr_b16 v[182:183], v213 offset:24832
    s_waitcnt lgkmcnt(14)
    v_mfma_f32_32x32x16_bf16 v[160:175], v[184:187], v[88:91], v[160:175]
    s_add_u32 m0, s39, 0
    s_add_u32 s35, s38, 0
    buffer_load_dwordx4 v221, s[52:55], s35 offen lds
    ds_read_b64_tr_b16 v[184:185], v214 offset:24576
    ds_read_b64_tr_b16 v[186:187], v214 offset:24832
    s_waitcnt lgkmcnt(14)
    v_mfma_f32_32x32x16_bf16 v[160:175], v[188:191], v[92:95], v[160:175]
    ds_read_b64_tr_b16 v[188:189], v215 offset:24576
    ds_read_b64_tr_b16 v[190:191], v215 offset:24832
    s_waitcnt lgkmcnt(14)
    v_mfma_f32_32x32x16_bf16 v[160:175], v[152:155], v[96:99], v[160:175]
    s_add_u32 m0, s39, 1024
    s_add_u32 s35, s38, 7168
    buffer_load_dwordx4 v221, s[52:55], s35 offen lds
    s_waitcnt lgkmcnt(12)
    v_mfma_f32_32x32x16_bf16 v[160:175], v[196:199], v[100:103], v[160:175]
    s_waitcnt lgkmcnt(10)
    v_mfma_f32_32x32x16_bf16 v[160:175], v[200:203], v[104:107], v[160:175]
    s_waitcnt lgkmcnt(8)
    v_mfma_f32_32x32x16_bf16 v[160:175], v[204:207], v[108:111], v[160:175]
    s_add_u32 m0, s39, 2048
    s_add_u32 s35, s38, 14336
    buffer_load_dwordx4 v221, s[52:55], s35 offen lds
    s_waitcnt lgkmcnt(6)
    v_mfma_f32_32x32x16_bf16 v[160:175], v[156:159], v[112:115], v[160:175]
    s_waitcnt lgkmcnt(4)
    v_mfma_f32_32x32x16_bf16 v[160:175], v[180:183], v[116:119], v[160:175]
    s_waitcnt lgkmcnt(2)
    v_mfma_f32_32x32x16_bf16 v[160:175], v[184:187], v[120:123], v[160:175]
    s_add_u32 m0, s39, 3072
    s_add_u32 s35, s38, 21504
    buffer_load_dwordx4 v221, s[52:55], s35 offen lds
    s_waitcnt lgkmcnt(0)
    v_mfma_f32_32x32x16_bf16 v[160:175], v[188:191], v[124:127], v[160:175]
    s_lshl_b32 s7, s4, 3
    s_add_u32 s7, s7, 149504
    v_lshlrev_b32 v8, 5, v3
    v_add_u32 v8, s7, v8
    v_dot2c_f32_bf16 v13, s17, v132
    v_dot2c_f32_bf16 v13, s17, v133
    v_dot2c_f32_bf16 v13, s17, v134
    v_dot2c_f32_bf16 v13, s17, v135
    v_dot2c_f32_bf16 v13, s17, v136
    s_add_u32 m0, s39, 4096
    s_add_u32 s35, s38, 28672
    buffer_load_dwordx4 v221, s[52:55], s35 offen lds
    v_dot2c_f32_bf16 v13, s17, v137
    v_dot2c_f32_bf16 v13, s17, v138
    v_dot2c_f32_bf16 v13, s17, v139
    v_dot2c_f32_bf16 v13, s17, v140
    v_dot2c_f32_bf16 v13, s17, v141
    v_dot2c_f32_bf16 v13, s17, v142
    v_dot2c_f32_bf16 v13, s17, v143
    v_dot2c_f32_bf16 v13, s17, v144
    v_dot2c_f32_bf16 v13, s17, v145
    v_dot2c_f32_bf16 v13, s17, v146
    v_dot2c_f32_bf16 v13, s17, v147
    v_dot2c_f32_bf16 v13, s17, v148
    v_dot2c_f32_bf16 v13, s17, v149
    v_dot2c_f32_bf16 v13, s17, v150
    v_dot2c_f32_bf16 v13, s17, v151
    v_dot2c_f32_bf16 v13, s17, v152
    v_dot2c_f32_bf16 v13, s17, v153
    v_dot2c_f32_bf16 v13, s17, v154
    s_add_u32 m0, s39, 5120
    s_add_u32 s35, s38, 35840
    buffer_load_dwordx4 v221, s[52:55], s35 offen lds
    v_dot2c_f32_bf16 v13, s17, v155
    v_dot2c_f32_bf16 v13, s17, v156
    v_dot2c_f32_bf16 v13, s17, v157
    v_dot2c_f32_bf16 v13, s17, v158
    v_dot2c_f32_bf16 v13, s17, v159
    s_nop 2
    v_mov_b32 v7, v13
    s_nop 1
    v_permlane32_swap_b32 v13, v7
    v_add_f32 v13, v13, v7
    v_cvt_pk_bf16_f32 v224, v13, v13
    v_lshlrev_b32 v7, 16, v224
    v_sub_f32 v13, v13, v7
    v_cvt_pk_bf16_f32 v225, v13, v13
    v_lshlrev_b32 v7, 16, v225
    v_sub_f32 v13, v13, v7
    v_and_b32 v224, 0xffff, v224
    v_or_b32 v224, v224, v7
    v_cvt_pk_bf16_f32 v225, v13, v5
    ds_write_b64 v8, v[224:225] offset:2048
    s_add_u32 m0, s39, 6144
    s_add_u32 s35, s38, 43008
    buffer_load_dwordx4 v221, s[52:55], s35 offen lds
    s_waitcnt lgkmcnt(0)
    s_barrier
    ds_read_b128 v[176:179], v11 offset:2048
    s_waitcnt lgkmcnt(0)
    v_mfma_f32_32x32x16_bf16 v[160:175], v[176:179], v[228:231], v[160:175]
    s_nop 11
    v_pk_mul_f32 v[160:161], v[160:161], v[226:227] op_sel_hi:[1,0]
    v_pk_mul_f32 v[162:163], v[162:163], v[226:227] op_sel_hi:[1,0]
    v_pk_mul_f32 v[164:165], v[164:165], v[226:227] op_sel_hi:[1,0]
    v_pk_mul_f32 v[166:167], v[166:167], v[226:227] op_sel_hi:[1,0]
    v_pk_mul_f32 v[168:169], v[168:169], v[226:227] op_sel_hi:[1,0]
    v_pk_mul_f32 v[170:171], v[170:171], v[226:227] op_sel_hi:[1,0]
    v_pk_mul_f32 v[172:173], v[172:173], v[226:227] op_sel_hi:[1,0]
    v_pk_mul_f32 v[174:175], v[174:175], v[226:227] op_sel_hi:[1,0]
    v_cvt_pk_bf16_f32 v184, v160, v161
    v_cvt_pk_bf16_f32 v185, v162, v163
    v_cvt_pk_bf16_f32 v186, v164, v165
    s_add_u32 m0, s39, 7168
    s_add_u32 s35, s38, 50176
    buffer_load_dwordx4 v221, s[52:55], s35 offen lds
    v_cvt_pk_bf16_f32 v187, v166, v167
    v_cvt_pk_bf16_f32 v188, v168, v169
    v_cvt_pk_bf16_f32 v189, v170, v171
    v_cvt_pk_bf16_f32 v190, v172, v173
    v_cvt_pk_bf16_f32 v191, v174, v175
    v_cndmask_b32 v190, 0, v190, s[32:33]
    v_cndmask_b32 v191, 0, v191, s[32:33]
    v_mfma_f32_32x32x16_bf16 v[160:175], v[232:235], v[184:187], 0
    s_nop 0
    v_mfma_f32_32x32x16_bf16 v[160:175], v[236:239], v[188:191], v[160:175]
    s_add_u32 m0, s39, 8192
    s_add_u32 s35, s38, 57344
    buffer_load_dwordx4 v221, s[52:55], s35 offen lds
    s_nop 8
    v_cndmask_b32 v172, v160, v172, s[32:33]
    v_cndmask_b32 v173, v161, v173, s[32:33]
    v_cndmask_b32 v174, v162, v174, s[32:33]
    v_cndmask_b32 v175, v163, v175, s[32:33]
    v_max3_f32 v128, v160, v161, v162
    v_min3_f32 v130, v160, v161, v162
    v_max3_f32 v128, v128, v163, v164
    v_min3_f32 v130, v130, v163, v164
    v_max3_f32 v128, v128, v165, v166
    v_min3_f32 v130, v130, v165, v166
    v_max3_f32 v128, v128, v167, v168
    v_min3_f32 v130, v130, v167, v168
    v_max3_f32 v128, v128, v169, v170
    v_min3_f32 v130, v130, v169, v170
    v_max3_f32 v128, v128, v171, v172
    v_min3_f32 v130, v130, v171, v172
    s_add_u32 m0, s39, 9216
    s_add_u32 s35, s38, 64512
    buffer_load_dwordx4 v221, s[52:55], s35 offen lds
    v_max3_f32 v128, v128, v173, v174
    v_min3_f32 v130, v130, v173, v174
    v_max_f32 v128, v128, v175
    v_min_f32 v130, v130, v175
    v_mov_b32 v140, v128
    v_mov_b32 v141, v130
    s_nop 0
    v_permlane32_swap_b32 v128, v140
    v_permlane32_swap_b32 v130, v141
    v_max_f32 v128, v128, v140
    v_min_f32 v130, v130, v141
    v_mul_f32 v128, s16, v128
    v_mul_f32 v130, s16, v130
    v_pk_fma_f32 v[144:145], v[160:161], s[16:17], v[130:131] op_sel_hi:[1,0,0] neg_lo:[1,0,0] neg_hi:[1,0,0]
    v_pk_fma_f32 v[160:161], v[160:161], s[16:17], v[128:129] op_sel_hi:[1,0,0] neg_lo:[0,0,1] neg_hi:[0,0,1]
    v_pk_fma_f32 v[146:147], v[162:163], s[16:17], v[130:131] op_sel_hi:[1,0,0] neg_lo:[1,0,0] neg_hi:[1,0,0]
    v_pk_fma_f32 v[162:163], v[162:163], s[16:17], v[128:129] op_sel_hi:[1,0,0] neg_lo:[0,0,1] neg_hi:[0,0,1]
    v_pk_fma_f32 v[148:149], v[164:165], s[16:17], v[130:131] op_sel_hi:[1,0,0] neg_lo:[1,0,0] neg_hi:[1,0,0]
    s_add_u32 m0, s39, 10240
    s_add_u32 s35, s38, 71680
    buffer_load_dwordx4 v221, s[52:55], s35 offen lds
    v_pk_fma_f32 v[164:165], v[164:165], s[16:17], v[128:129] op_sel_hi:[1,0,0] neg_lo:[0,0,1] neg_hi:[0,0,1]
    v_pk_fma_f32 v[150:151], v[166:167], s[16:17], v[130:131] op_sel_hi:[1,0,0] neg_lo:[1,0,0] neg_hi:[1,0,0]
    v_pk_fma_f32 v[166:167], v[166:167], s[16:17], v[128:129] op_sel_hi:[1,0,0] neg_lo:[0,0,1] neg_hi:[0,0,1]
    v_pk_fma_f32 v[152:153], v[168:169], s[16:17], v[130:131] op_sel_hi:[1,0,0] neg_lo:[1,0,0] neg_hi:[1,0,0]
    v_pk_fma_f32 v[168:169], v[168:169], s[16:17], v[128:129] op_sel_hi:[1,0,0] neg_lo:[0,0,1] neg_hi:[0,0,1]
    v_pk_fma_f32 v[154:155], v[170:171], s[16:17], v[130:131] op_sel_hi:[1,0,0] neg_lo:[1,0,0] neg_hi:[1,0,0]
    v_pk_fma_f32 v[170:171], v[170:171], s[16:17], v[128:129] op_sel_hi:[1,0,0] neg_lo:[0,0,1] neg_hi:[0,0,1]
    v_pk_fma_f32 v[156:157], v[172:173], s[16:17], v[130:131] op_sel_hi:[1,0,0] neg_lo:[1,0,0] neg_hi:[1,0,0]
    v_pk_fma_f32 v[172:173], v[172:173], s[16:17], v[128:129] op_sel_hi:[1,0,0] neg_lo:[0,0,1] neg_hi:[0,0,1]
    v_pk_fma_f32 v[158:159], v[174:175], s[16:17], v[130:131] op_sel_hi:[1,0,0] neg_lo:[1,0,0] neg_hi:[1,0,0]
    v_pk_fma_f32 v[174:175], v[174:175], s[16:17], v[128:129] op_sel_hi:[1,0,0] neg_lo:[0,0,1] neg_hi:[0,0,1]
    v_exp_f32 v144, v144
    v_exp_f32 v160, v160
    v_exp_f32 v145, v145
    v_exp_f32 v161, v161
    s_add_u32 m0, s39, 11264
    s_add_u32 s35, s38, 78848
    buffer_load_dwordx4 v221, s[52:55], s35 offen lds
    v_exp_f32 v146, v146
    v_exp_f32 v162, v162
    v_exp_f32 v147, v147
    v_exp_f32 v163, v163
    v_exp_f32 v148, v148
    v_exp_f32 v164, v164
    v_exp_f32 v149, v149
    v_exp_f32 v165, v165
    v_exp_f32 v150, v150
    v_exp_f32 v166, v166
    v_exp_f32 v151, v151
    v_exp_f32 v167, v167
    s_add_u32 m0, s39, 12288
    s_add_u32 s35, s38, 86016
    buffer_load_dwordx4 v221, s[52:55], s35 offen lds
    v_exp_f32 v152, v152
    v_exp_f32 v168, v168
    v_exp_f32 v153, v153
    v_exp_f32 v169, v169
    v_exp_f32 v154, v154
    v_exp_f32 v170, v170
    v_exp_f32 v155, v155
    v_exp_f32 v171, v171
    v_exp_f32 v156, v156
    v_exp_f32 v172, v172
    v_exp_f32 v157, v157
    s_add_u32 m0, s39, 13312
    s_add_u32 s35, s38, 93184
    buffer_load_dwordx4 v221, s[52:55], s35 offen lds
    v_exp_f32 v173, v173
    v_exp_f32 v158, v158
    v_exp_f32 v174, v174
    v_exp_f32 v159, v159
    v_exp_f32 v175, v175
    v_pk_add_f32 v[132:133], v[160:161], v[162:163]
    v_pk_add_f32 v[134:135], v[144:145], v[146:147]
    v_pk_add_f32 v[132:133], v[132:133], v[164:165]
    v_lshrrev_b32 v222, 2, v1
    v_mul_u32_u24 v222, 896, v222
    v_and_b32 v220, 3, v1
    v_lshl_add_u32 v222, v220, 4, v222
    s_lshl_b32 s35, s4, 11
    s_add_u32 m0, s35, 57344
    s_nop 0
    buffer_load_dwordx4 v222, s[40:43], s85 offen lds
    s_add_u32 m0, s35, 58368
    s_add_u32 s35, s85, 14336
    buffer_load_dwordx4 v222, s[40:43], s35 offen lds
    v_pk_add_f32 v[134:135], v[134:135], v[148:149]
    v_pk_add_f32 v[132:133], v[132:133], v[166:167]
    v_pk_add_f32 v[134:135], v[134:135], v[150:151]
    v_pk_add_f32 v[132:133], v[132:133], v[168:169]
    v_pk_add_f32 v[134:135], v[134:135], v[152:153]
    v_pk_add_f32 v[132:133], v[132:133], v[170:171]
    v_pk_add_f32 v[134:135], v[134:135], v[154:155]
    v_pk_add_f32 v[136:137], v[172:173], v[174:175]
    v_pk_add_f32 v[138:139], v[156:157], v[158:159]
    v_pk_fma_f32 v[132:133], v[136:137], v[6:7], v[132:133] op_sel_hi:[1,0,1]
    v_pk_fma_f32 v[134:135], v[138:139], v[6:7], v[134:135] op_sel_hi:[1,0,1]
    v_add_f32 v132, v132, v133
    v_add_f32 v134, v134, v135
    v_mov_b32 v140, v132
    v_mov_b32 v141, v134
    s_nop 0
    v_permlane32_swap_b32 v132, v140
    v_permlane32_swap_b32 v134, v141
    s_add_u32 s35, s84, 100352
    buffer_load_dwordx4 a[56:59], v221, s[60:63], s35 offen
    v_add_f32 v132, v132, v140
    v_add_f32 v134, v134, v141
    v_rcp_f32 v132, v132
    v_rcp_f32 v134, v134
    v_mul_f32 v136, v132, v6
    v_mul_f32 v138, v134, v6
    v_pk_mul_f32 v[160:161], v[160:161], v[132:133] op_sel_hi:[1,0]
    v_pk_mul_f32 v[144:145], v[144:145], v[134:135] op_sel_hi:[1,0]
    v_pk_mul_f32 v[162:163], v[162:163], v[132:133] op_sel_hi:[1,0]
    v_pk_mul_f32 v[146:147], v[146:147], v[134:135] op_sel_hi:[1,0]
    v_pk_mul_f32 v[164:165], v[164:165], v[132:133] op_sel_hi:[1,0]
    v_pk_mul_f32 v[148:149], v[148:149], v[134:135] op_sel_hi:[1,0]
    v_pk_mul_f32 v[166:167], v[166:167], v[132:133] op_sel_hi:[1,0]
    v_pk_mul_f32 v[150:151], v[150:151], v[134:135] op_sel_hi:[1,0]
    v_pk_mul_f32 v[168:169], v[168:169], v[132:133] op_sel_hi:[1,0]
    v_pk_mul_f32 v[152:153], v[152:153], v[134:135] op_sel_hi:[1,0]
    v_pk_mul_f32 v[170:171], v[170:171], v[132:133] op_sel_hi:[1,0]
    s_add_u32 s35, s84, 107520
    buffer_load_dwordx4 a[60:63], v221, s[60:63], s35 offen
    v_pk_mul_f32 v[154:155], v[154:155], v[134:135] op_sel_hi:[1,0]
    v_pk_mul_f32 v[172:173], v[172:173], v[136:137] op_sel_hi:[1,0]
    v_pk_mul_f32 v[156:157], v[156:157], v[138:139] op_sel_hi:[1,0]
    v_pk_mul_f32 v[174:175], v[174:175], v[136:137] op_sel_hi:[1,0]
    v_pk_mul_f32 v[158:159], v[158:159], v[138:139] op_sel_hi:[1,0]
    v_cvt_pk_bf16_f32 v240, v160, v161
    v_cvt_pk_bf16_f32 v248, v144, v145
    v_cvt_pk_bf16_f32 v241, v162, v163
    v_cvt_pk_bf16_f32 v249, v146, v147
    v_cvt_pk_bf16_f32 v242, v164, v165
    v_cvt_pk_bf16_f32 v250, v148, v149
    v_cvt_pk_bf16_f32 v243, v166, v167
    v_cvt_pk_bf16_f32 v251, v150, v151
    v_cvt_pk_bf16_f32 v244, v168, v169
    v_cvt_pk_bf16_f32 v252, v152, v153
    v_cvt_pk_bf16_f32 v245, v170, v171
    v_cvt_pk_bf16_f32 v253, v154, v155
    v_cvt_pk_bf16_f32 v246, v172, v173
    s_add_u32 s35, s84, 114688
    buffer_load_dwordx4 a[64:67], v221, s[60:63], s35 offen
    v_cvt_pk_bf16_f32 v254, v156, v157
    v_cvt_pk_bf16_f32 v247, v174, v175
    v_cvt_pk_bf16_f32 v255, v158, v159
    s_lshl_b32 s7, s6, 8
    v_mov_b32 v8, s7
    s_lshl_b32 s7, s91, 8
    v_writelane_b32 v8, s7, 1
    s_cmp_eq_u32 s4, 0
    s_cselect_b32 s8, 0x1580000, 0x40000000
    buffer_load_dword a253, v8, s[72:75], s8 offen sc1
    v_bfe_u32 v7, v1, 2, 2
    v_lshlrev_b32 v80, 7, v7
    v_and_b32 v8, 3, v1
    v_lshl_add_u32 v80, v8, 3, v80
    v_bfe_u32 v8, v1, 4, 1
    v_lshl_add_u32 v80, v8, 5, v80
    v_bfe_u32 v8, v1, 3, 1
    v_lshlrev_b32 v8, 6, v8
    v_xor_b32 v80, v80, v8
    v_lshl_add_u32 v80, v4, 9, v80
    s_lshr_b32 s7, s4, 1
    s_lshl_b32 s7, s7, 6
    v_xor_b32 v80, s7, v80
    v_xor_b32 v82, 64, v80
    v_add_u32 v80, s39, v80
    v_add_u32 v82, s39, v82
    v_lshlrev_b32 v7, 9, v4
    v_sub_u32 v81, v80, v7
    v_sub_u32 v83, v82, v7
    v_lshlrev_b32 v84, 6, v3
    v_lshl_add_u32 v84, v4, 3, v84
    s_lshl_b32 s7, s4, 11
    s_add_u32 s7, s7, 57344
    v_add_u32 v84, s7, v84
    s_waitcnt vmcnt(4)
    ds_read_b64_tr_b16 a[160:161], v80 offset:0
    ds_read_b64_tr_b16 a[162:163], v80 offset:1024
    ds_read_b64_tr_b16 a[164:165], v82 offset:0
    ds_read_b64_tr_b16 a[166:167], v82 offset:1024
    ds_read_b64_tr_b16 a[168:169], v80 offset:2048
    ds_read_b64_tr_b16 a[170:171], v81 offset:3072
    ds_read_b64_tr_b16 a[172:173], v82 offset:2048
    ds_read_b64_tr_b16 a[174:175], v83 offset:3072
    ds_read_b64_tr_b16 a[176:177], v80 offset:3584
    ds_read_b64_tr_b16 a[178:179], v80 offset:4608
    ds_read_b64_tr_b16 a[180:181], v82 offset:3584
    ds_read_b64_tr_b16 a[182:183], v82 offset:4608
    ds_read_b64_tr_b16 a[184:185], v80 offset:5632
    ds_read_b64_tr_b16 a[186:187], v81 offset:6656
    ds_read_b64_tr_b16 a[188:189], v82 offset:5632
    ds_read_b64_tr_b16 a[190:191], v83 offset:6656
    ds_read_b64_tr_b16 a[192:193], v80 offset:7168
    ds_read_b64_tr_b16 a[194:195], v80 offset:8192
    ds_read_b64_tr_b16 a[196:197], v82 offset:7168
    ds_read_b64_tr_b16 a[198:199], v82 offset:8192
    ds_read_b64_tr_b16 a[200:201], v80 offset:9216
    ds_read_b64_tr_b16 a[202:203], v81 offset:10240
    ds_read_b64_tr_b16 a[204:205], v82 offset:9216
    ds_read_b64_tr_b16 a[206:207], v83 offset:10240
    ds_read_b64_tr_b16 a[208:209], v80 offset:10752
    ds_read_b64_tr_b16 a[210:211], v80 offset:11776
    ds_read_b64_tr_b16 a[212:213], v82 offset:10752
    ds_read_b64_tr_b16 a[214:215], v82 offset:11776
    ds_read_b64_tr_b16 a[216:217], v80 offset:12800
    ds_read_b64_tr_b16 a[218:219], v81 offset:13824
    ds_read_b64_tr_b16 a[220:221], v82 offset:12800
    ds_read_b64_tr_b16 a[222:223], v83 offset:13824
    ds_read_b64 a[240:241], v84 offset:0
    ds_read_b64 a[242:243], v84 offset:16
    ds_read_b64 a[244:245], v84 offset:32
    ds_read_b64 a[246:247], v84 offset:48
    v_lshlrev_b32 v219, 4, v0
    s_lshl_b32 s13, s6, 16
    s_add_u32 s13, s13, 0xf00000
    v_mov_b32 v128, 0
    v_mov_b32 v129, 0
    v_mov_b32 v130, 0
    v_mov_b32 v131, 0
    v_mov_b32 v132, 0
    v_mov_b32 v133, 0
    v_mov_b32 v134, 0
    v_mov_b32 v135, 0
    s_waitcnt vmcnt(0)
    v_accvgpr_read_b32 v7, a253
    s_cmp_lg_u32 s4, 0
    s_cbranch_scc1 L_sequential_preLN__linear_kernel_hedgehog__glu_gated_geglu__prompt_kernel_11
    s_lshl_b32 s7, s6, 8
    v_mov_b32 v8, s7
    s_lshl_b32 s7, s91, 8
    v_writelane_b32 v8, s7, 1
    s_mov_b32 s8, 0x1580000
    v_cmp_ne_u32 vcc, 16, v7
    s_nop 0
    s_cmp_eq_u64 vcc, 0
    s_cbranch_scc1 L_sequential_preLN__linear_kernel_hedgehog__glu_gated_geglu__prompt_kernel_11
    s_mov_b32 s34, 0
L_sequential_preLN__linear_kernel_hedgehog__glu_gated_geglu__prompt_kernel_12:
    buffer_load_dword v7, v8, s[72:75], s8 offen sc1
    s_waitcnt vmcnt(0)
    v_cmp_ne_u32 vcc, 16, v7
    s_nop 0
    s_cmp_eq_u64 vcc, 0
    s_cbranch_scc1 L_sequential_preLN__linear_kernel_hedgehog__glu_gated_geglu__prompt_kernel_13
    s_sleep 1
    s_add_u32 s34, s34, 1
    s_cmp_lt_u32 s34, 4194304
    s_cbranch_scc1 L_sequential_preLN__linear_kernel_hedgehog__glu_gated_geglu__prompt_kernel_12
L_sequential_preLN__linear_kernel_hedgehog__glu_gated_geglu__prompt_kernel_13:
L_sequential_preLN__linear_kernel_hedgehog__glu_gated_geglu__prompt_kernel_11:
    s_waitcnt lgkmcnt(0)
    s_barrier
    s_add_u32 s9, s13, 0
    buffer_load_dwordx4 v[16:19], v219, s[72:75], s9 offen sc1
    s_add_u32 s9, s13, 4096
    buffer_load_dwordx4 v[20:23], v219, s[72:75], s9 offen sc1
    s_add_u32 s9, s13, 8192
    buffer_load_dwordx4 v[24:27], v219, s[72:75], s9 offen sc1
    s_add_u32 s9, s13, 12288
    buffer_load_dwordx4 v[28:31], v219, s[72:75], s9 offen sc1
    s_add_u32 s9, s13, 16384
    buffer_load_dwordx4 v[32:35], v219, s[72:75], s9 offen sc1
    s_add_u32 s9, s13, 20480
    buffer_load_dwordx4 v[36:39], v219, s[72:75], s9 offen sc1
    s_add_u32 s9, s13, 24576
    buffer_load_dwordx4 v[40:43], v219, s[72:75], s9 offen sc1
    s_add_u32 s9, s13, 28672
    buffer_load_dwordx4 v[44:47], v219, s[72:75], s9 offen sc1
    s_add_u32 s9, s13, 32768
    buffer_load_dwordx4 v[48:51], v219, s[72:75], s9 offen sc1
    s_add_u32 s9, s13, 36864
    buffer_load_dwordx4 v[52:55], v219, s[72:75], s9 offen sc1
    s_add_u32 s9, s13, 40960
    buffer_load_dwordx4 v[56:59], v219, s[72:75], s9 offen sc1
    s_add_u32 s9, s13, 45056
    buffer_load_dwordx4 v[60:63], v219, s[72:75], s9 offen sc1
    s_add_u32 s9, s13, 49152
    buffer_load_dwordx4 v[64:67], v219, s[72:75], s9 offen sc1
    s_add_u32 s9, s13, 53248
    buffer_load_dwordx4 v[68:71], v219, s[72:75], s9 offen sc1
    s_add_u32 s9, s13, 57344
    buffer_load_dwordx4 v[72:75], v219, s[72:75], s9 offen sc1
    s_add_u32 s9, s13, 61440
    buffer_load_dwordx4 v[76:79], v219, s[72:75], s9 offen sc1
    s_waitcnt vmcnt(15)
    v_dot2c_f32_bf16 v128, s18, v16
    v_dot2c_f32_bf16 v129, s19, v16
    v_dot2c_f32_bf16 v130, s18, v17
    v_dot2c_f32_bf16 v131, s19, v17
    v_dot2c_f32_bf16 v132, s18, v18
    v_dot2c_f32_bf16 v133, s19, v18
    v_dot2c_f32_bf16 v134, s18, v19
    v_dot2c_f32_bf16 v135, s19, v19
    s_waitcnt vmcnt(14)
    v_dot2c_f32_bf16 v128, s18, v20
    v_dot2c_f32_bf16 v129, s19, v20
    v_dot2c_f32_bf16 v130, s18, v21
    v_dot2c_f32_bf16 v131, s19, v21
    v_dot2c_f32_bf16 v132, s18, v22
    v_dot2c_f32_bf16 v133, s19, v22
    v_dot2c_f32_bf16 v134, s18, v23
    v_dot2c_f32_bf16 v135, s19, v23
    s_waitcnt vmcnt(13)
    v_dot2c_f32_bf16 v128, s18, v24
    v_dot2c_f32_bf16 v129, s19, v24
    v_dot2c_f32_bf16 v130, s18, v25
    v_dot2c_f32_bf16 v131, s19, v25
    v_dot2c_f32_bf16 v132, s18, v26
    v_dot2c_f32_bf16 v133, s19, v26
    v_dot2c_f32_bf16 v134, s18, v27
    v_dot2c_f32_bf16 v135, s19, v27
    s_waitcnt vmcnt(12)
    v_dot2c_f32_bf16 v128, s18, v28
    v_dot2c_f32_bf16 v129, s19, v28
    v_dot2c_f32_bf16 v130, s18, v29
    v_dot2c_f32_bf16 v131, s19, v29
    v_dot2c_f32_bf16 v132, s18, v30
    v_dot2c_f32_bf16 v133, s19, v30
    v_dot2c_f32_bf16 v134, s18, v31
    v_dot2c_f32_bf16 v135, s19, v31
    s_waitcnt vmcnt(11)
    v_dot2c_f32_bf16 v128, s18, v32
    v_dot2c_f32_bf16 v129, s19, v32
    v_dot2c_f32_bf16 v130, s18, v33
    v_dot2c_f32_bf16 v131, s19, v33
    v_dot2c_f32_bf16 v132, s18, v34
    v_dot2c_f32_bf16 v133, s19, v34
    v_dot2c_f32_bf16 v134, s18, v35
    v_dot2c_f32_bf16 v135, s19, v35
    s_waitcnt vmcnt(10)
    v_dot2c_f32_bf16 v128, s18, v36
    v_dot2c_f32_bf16 v129, s19, v36
    v_dot2c_f32_bf16 v130, s18, v37
    v_dot2c_f32_bf16 v131, s19, v37
    v_dot2c_f32_bf16 v132, s18, v38
    v_dot2c_f32_bf16 v133, s19, v38
    v_dot2c_f32_bf16 v134, s18, v39
    v_dot2c_f32_bf16 v135, s19, v39
    s_waitcnt vmcnt(9)
    v_dot2c_f32_bf16 v128, s18, v40
    v_dot2c_f32_bf16 v129, s19, v40
    v_dot2c_f32_bf16 v130, s18, v41
    v_dot2c_f32_bf16 v131, s19, v41
    v_dot2c_f32_bf16 v132, s18, v42
    s_add_u32 s35, s36, 0
    s_add_u32 m0, s37, 0
    s_nop 0
    buffer_load_dwordx4 v2, s[72:75], s35 offen offset:0 sc1 lds
    buffer_load_dwordx4 v2, s[72:75], s35 offen offset:1024 sc1 lds
    buffer_load_dwordx4 v2, s[72:75], s35 offen offset:2048 sc1 lds
    buffer_load_dwordx4 v2, s[72:75], s35 offen offset:3072 sc1 lds
    v_dot2c_f32_bf16 v133, s19, v42
    v_dot2c_f32_bf16 v134, s18, v43
    v_dot2c_f32_bf16 v135, s19, v43
    s_waitcnt vmcnt(12)
    v_dot2c_f32_bf16 v128, s18, v44
    v_dot2c_f32_bf16 v129, s19, v44
    v_dot2c_f32_bf16 v130, s18, v45
    v_dot2c_f32_bf16 v131, s19, v45
    v_dot2c_f32_bf16 v132, s18, v46
    v_dot2c_f32_bf16 v133, s19, v46
    v_dot2c_f32_bf16 v134, s18, v47
    v_dot2c_f32_bf16 v135, s19, v47
    s_waitcnt vmcnt(11)
    v_dot2c_f32_bf16 v128, s18, v48
    v_dot2c_f32_bf16 v129, s19, v48
    v_dot2c_f32_bf16 v130, s18, v49
    v_dot2c_f32_bf16 v131, s19, v49
    v_dot2c_f32_bf16 v132, s18, v50
    v_dot2c_f32_bf16 v133, s19, v50
    v_dot2c_f32_bf16 v134, s18, v51
    v_dot2c_f32_bf16 v135, s19, v51
    s_waitcnt vmcnt(10)
    v_dot2c_f32_bf16 v128, s18, v52
    v_dot2c_f32_bf16 v129, s19, v52
    v_dot2c_f32_bf16 v130, s18, v53
    v_dot2c_f32_bf16 v131, s19, v53
    v_dot2c_f32_bf16 v132, s18, v54
    v_dot2c_f32_bf16 v133, s19, v54
    v_dot2c_f32_bf16 v134, s18, v55
    v_dot2c_f32_bf16 v135, s19, v55
    s_waitcnt vmcnt(9)
    v_dot2c_f32_bf16 v128, s18, v56
    v_dot2c_f32_bf16 v129, s19, v56
    v_dot2c_f32_bf16 v130, s18, v57
    v_dot2c_f32_bf16 v131, s19, v57
    v_dot2c_f32_bf16 v132, s18, v58
    v_dot2c_f32_bf16 v133, s19, v58
    v_dot2c_f32_bf16 v134, s18, v59
    v_dot2c_f32_bf16 v135, s19, v59
    s_waitcnt vmcnt(8)
    v_dot2c_f32_bf16 v128, s18, v60
    v_dot2c_f32_bf16 v129, s19, v60
    v_dot2c_f32_bf16 v130, s18, v61
    v_dot2c_f32_bf16 v131, s19, v61
    v_dot2c_f32_bf16 v132, s18, v62
    v_dot2c_f32_bf16 v133, s19, v62
    v_dot2c_f32_bf16 v134, s18, v63
    s_add_u32 s35, s36, 4096
    s_add_u32 m0, s37, 4096
    s_nop 0
    buffer_load_dwordx4 v2, s[72:75], s35 offen offset:0 sc1 lds
    buffer_load_dwordx4 v2, s[72:75], s35 offen offset:1024 sc1 lds
    buffer_load_dwordx4 v2, s[72:75], s35 offen offset:2048 sc1 lds
    v_dot2c_f32_bf16 v135, s19, v63
    s_waitcnt vmcnt(10)
    v_dot2c_f32_bf16 v128, s18, v64
    v_dot2c_f32_bf16 v129, s19, v64
    v_dot2c_f32_bf16 v130, s18, v65
    v_dot2c_f32_bf16 v131, s19, v65
    v_dot2c_f32_bf16 v132, s18, v66
    v_dot2c_f32_bf16 v133, s19, v66
    v_dot2c_f32_bf16 v134, s18, v67
    v_dot2c_f32_bf16 v135, s19, v67
    s_waitcnt vmcnt(9)
    v_dot2c_f32_bf16 v128, s18, v68
    v_dot2c_f32_bf16 v129, s19, v68
    v_dot2c_f32_bf16 v130, s18, v69
    v_dot2c_f32_bf16 v131, s19, v69
    v_dot2c_f32_bf16 v132, s18, v70
    v_dot2c_f32_bf16 v133, s19, v70
    v_dot2c_f32_bf16 v134, s18, v71
    v_dot2c_f32_bf16 v135, s19, v71
    s_waitcnt vmcnt(8)
    v_dot2c_f32_bf16 v128, s18, v72
    v_dot2c_f32_bf16 v129, s19, v72
    v_dot2c_f32_bf16 v130, s18, v73
    v_dot2c_f32_bf16 v131, s19, v73
    v_dot2c_f32_bf16 v132, s18, v74
    v_dot2c_f32_bf16 v133, s19, v74
    v_dot2c_f32_bf16 v134, s18, v75
    v_dot2c_f32_bf16 v135, s19, v75
    s_waitcnt vmcnt(7)
    v_dot2c_f32_bf16 v128, s18, v76
    v_dot2c_f32_bf16 v129, s19, v76
    v_dot2c_f32_bf16 v130, s18, v77
    v_dot2c_f32_bf16 v131, s19, v77
    v_dot2c_f32_bf16 v132, s18, v78
    v_dot2c_f32_bf16 v133, s19, v78
    v_dot2c_f32_bf16 v134, s18, v79
    v_dot2c_f32_bf16 v135, s19, v79
    v_cvt_pk_bf16_f32 v176, v128, v129
    v_cvt_pk_bf16_f32 v177, v130, v131
    v_cvt_pk_bf16_f32 v178, v132, v133
    v_cvt_pk_bf16_f32 v179, v134, v135
    v_add_u32 v219, 152576, v219
    ds_write_b128 v219, v[176:179]
    v_add_u32 v219, 152576, v2
    s_waitcnt lgkmcnt(0)
    s_barrier
    ds_read_b128 v[176:179], v219 offset:0
    ds_read_b128 v[180:183], v219 offset:1024
    ds_read_b128 v[184:187], v219 offset:2048
    ds_read_b128 v[188:191], v219 offset:3072
    s_waitcnt lgkmcnt(3)
    v_mfma_f32_32x32x16_bf16 v[128:143], v[176:179], v[240:243], 0
    s_waitcnt lgkmcnt(2)
    v_mfma_f32_32x32x16_bf16 v[128:143], v[180:183], v[244:247], v[128:143]
    s_waitcnt lgkmcnt(1)
    v_mfma_f32_32x32x16_bf16 v[128:143], v[184:187], v[248:251], v[128:143]
    s_waitcnt lgkmcnt(0)
    v_mfma_f32_32x32x16_bf16 v[128:143], v[188:191], v[252:255], v[128:143]
    s_lshl_b32 s9, s20, 4
    s_add_u32 s9, s9, s6
    s_lshl_b32 s9, s9, 11
    s_add_u32 s9, s9, 0x1100000
    s_nop 7
    v_mov_b32 v7, v140
    v_mov_b32 v226, v140
    s_nop 1
    v_permlane32_swap_b32 v7, v226
    v_cvt_pk_bf16_f32 v226, v226, v226
    v_lshlrev_b32 v226, 16, v226
    v_add_f32 v226, 0x358637bd, v226
    v_cvt_pk_bf16_f32 v226, v226, v226
    v_lshlrev_b32 v226, 16, v226
    v_rcp_f32 v226, v226
    s_nop 0
    v_pk_mul_f32 v[128:129], v[128:129], v[226:227] op_sel_hi:[1,0]
    v_pk_mul_f32 v[130:131], v[130:131], v[226:227] op_sel_hi:[1,0]
    v_pk_mul_f32 v[132:133], v[132:133], v[226:227] op_sel_hi:[1,0]
    v_pk_mul_f32 v[134:135], v[134:135], v[226:227] op_sel_hi:[1,0]
    v_pk_mul_f32 v[136:137], v[136:137], v[226:227] op_sel_hi:[1,0]
    v_pk_mul_f32 v[138:139], v[138:139], v[226:227] op_sel_hi:[1,0]
    v_pk_mul_f32 v[140:141], v[140:141], v[226:227] op_sel_hi:[1,0]
    v_pk_mul_f32 v[142:143], v[142:143], v[226:227] op_sel_hi:[1,0]
    v_cvt_pk_bf16_f32 v176, v128, v129
    v_cvt_pk_bf16_f32 v177, v130, v131
    v_cvt_pk_bf16_f32 v178, v132, v133
    v_cvt_pk_bf16_f32 v179, v134, v135
    v_cvt_pk_bf16_f32 v180, v136, v137
    v_cvt_pk_bf16_f32 v181, v138, v139
    v_cvt_pk_bf16_f32 v182, v140, v141
    v_cvt_pk_bf16_f32 v183, v142, v143
    v_cndmask_b32 v182, 0, v182, s[32:33]
    v_cndmask_b32 v183, 0, v183, s[32:33]
    buffer_store_dwordx4 v[176:179], v2, s[72:75], s9 offen offset:0 sc1
    buffer_store_dwordx4 v[180:183], v2, s[72:75], s9 offen offset:1024 sc1
    v_mov_b32 v22, v221
    v_accvgpr_read_b32 v24, a240
    v_accvgpr_read_b32 v25, a241
    v_accvgpr_read_b32 v26, a242
    v_accvgpr_read_b32 v27, a243
    v_accvgpr_read_b32 v28, a244
    v_accvgpr_read_b32 v29, a245
    v_accvgpr_read_b32 v30, a246
    v_accvgpr_read_b32 v31, a247
    s_add_u32 s35, s36, 28672
    s_add_u32 m0, s37, 28672
    s_nop 0
    buffer_load_dwordx4 v2, s[72:75], s35 offen offset:0 sc1 lds
    buffer_load_dwordx4 v2, s[72:75], s35 offen offset:1024 sc1 lds
    buffer_load_dwordx4 v2, s[72:75], s35 offen offset:2048 sc1 lds
    buffer_load_dwordx4 v2, s[72:75], s35 offen offset:3072 sc1 lds
    s_add_u32 s35, s36, 32768
    s_add_u32 m0, s37, 32768
    s_nop 0
    buffer_load_dwordx4 v2, s[72:75], s35 offen offset:0 sc1 lds
    buffer_load_dwordx4 v2, s[72:75], s35 offen offset:1024 sc1 lds
    buffer_load_dwordx4 v2, s[72:75], s35 offen offset:2048 sc1 lds
    s_add_u32 s35, s36, 57344
    s_add_u32 m0, s37, 57344
    s_nop 0
    buffer_load_dwordx4 v2, s[72:75], s35 offen offset:0 sc1 lds
    buffer_load_dwordx4 v2, s[72:75], s35 offen offset:1024 sc1 lds
    buffer_load_dwordx4 v2, s[72:75], s35 offen offset:2048 sc1 lds
    buffer_load_dwordx4 v2, s[72:75], s35 offen offset:3072 sc1 lds
    s_waitcnt vmcnt(11)
    s_barrier
    s_cmp_lg_u32 s4, 0
    s_cbranch_scc1 L_sequential_preLN__linear_kernel_hedgehog__glu_gated_geglu__prompt_kernel_14
    s_mov_b64 s[30:31], exec
    s_mov_b64 exec, 1
    v_mov_b32 v7, 1
    buffer_atomic_add v7, off, s[72:75], s22 offset:0 sc1
    s_mov_b64 exec, s[30:31]
L_sequential_preLN__linear_kernel_hedgehog__glu_gated_geglu__prompt_kernel_14:
    v_lshlrev_b32 v9, 2, v0
    v_mov_b32 v10, 0x40000000
    v_cmp_gt_u32 vcc, 224, v0
    s_nop 1
    v_cndmask_b32 v10, v10, v9, vcc
    s_mul_i32 s7, s91, 25088
    s_add_u32 s7, s7, 0x15a0000
    s_add_u32 s9, s7, 0
    buffer_load_dword v160, v10, s[72:75], s9 offen offset:0 sc1
    buffer_load_dword v161, v10, s[72:75], s9 offen offset:896 sc1
    buffer_load_dword v162, v10, s[72:75], s9 offen offset:1792 sc1
    buffer_load_dword v163, v10, s[72:75], s9 offen offset:2688 sc1
    s_add_u32 s9, s7, 3584
    buffer_load_dword v164, v10, s[72:75], s9 offen offset:0 sc1
    buffer_load_dword v165, v10, s[72:75], s9 offen offset:896 sc1
    buffer_load_dword v166, v10, s[72:75], s9 offen offset:1792 sc1
    buffer_load_dword v167, v10, s[72:75], s9 offen offset:2688 sc1
    s_add_u32 s9, s7, 7168
    buffer_load_dword v168, v10, s[72:75], s9 offen offset:0 sc1
    buffer_load_dword v169, v10, s[72:75], s9 offen offset:896 sc1
    buffer_load_dword v170, v10, s[72:75], s9 offen offset:1792 sc1
    buffer_load_dword v171, v10, s[72:75], s9 offen offset:2688 sc1
    s_add_u32 s9, s7, 10752
    buffer_load_dword v172, v10, s[72:75], s9 offen offset:0 sc1
    buffer_load_dword v173, v10, s[72:75], s9 offen offset:896 sc1
    buffer_load_dword v174, v10, s[72:75], s9 offen offset:1792 sc1
    buffer_load_dword v175, v10, s[72:75], s9 offen offset:2688 sc1
    s_add_u32 s9, s7, 14336
    buffer_load_dword v176, v10, s[72:75], s9 offen offset:0 sc1
    buffer_load_dword v177, v10, s[72:75], s9 offen offset:896 sc1
    buffer_load_dword v178, v10, s[72:75], s9 offen offset:1792 sc1
    buffer_load_dword v179, v10, s[72:75], s9 offen offset:2688 sc1
    s_add_u32 s9, s7, 17920
    buffer_load_dword v180, v10, s[72:75], s9 offen offset:0 sc1
    buffer_load_dword v181, v10, s[72:75], s9 offen offset:896 sc1
    buffer_load_dword v182, v10, s[72:75], s9 offen offset:1792 sc1
    buffer_load_dword v183, v10, s[72:75], s9 offen offset:2688 sc1
    s_add_u32 s9, s7, 21504
    buffer_load_dword v184, v10, s[72:75], s9 offen offset:0 sc1
    buffer_load_dword v185, v10, s[72:75], s9 offen offset:896 sc1
    buffer_load_dword v186, v10, s[72:75], s9 offen offset:1792 sc1
    buffer_load_dword v187, v10, s[72:75], s9 offen offset:2688 sc1
    s_xor_b32 s7, s28, 0
    s_lshl_b32 s13, s7, 15
    s_lshl_b32 s7, s4, 13
    s_add_u32 s13, s13, s7
    s_add_u32 s13, s13, 0x1100000
    s_cmp_lt_u32 s89, 14
    s_cselect_b32 s13, s13, 0x40000000
    s_xor_b32 s7, s28, 1
    s_lshl_b32 s14, s7, 15
    s_lshl_b32 s7, s4, 13
    s_add_u32 s14, s14, s7
    s_add_u32 s14, s14, 0x1100000
    s_cmp_lt_u32 s89, 14
    s_cselect_b32 s14, s14, 0x40000000
    s_mul_i32 s7, s4, 8192
    s_add_u32 s8, s7, 86016
    v_bfe_u32 v7, v1, 2, 2
    v_lshlrev_b32 v9, 7, v7
    v_and_b32 v8, 3, v1
    v_lshl_add_u32 v9, v8, 3, v9
    v_bfe_u32 v8, v1, 4, 1
    v_lshl_add_u32 v9, v8, 5, v9
    v_bfe_u32 v8, v1, 3, 1
    v_lshlrev_b32 v8, 6, v8
    v_xor_b32 v9, v9, v8
    v_lshl_add_u32 v9, v4, 9, v9
    s_lshr_b32 s7, s4, 1
    s_lshl_b32 s7, s7, 6
    v_xor_b32 v9, s7, v9
    v_xor_b32 v10, 64, v9
    v_add_u32 v9, s8, v9
    v_add_u32 v10, s8, v10
    v_add_u32 v11, s8, v2
    ds_write_b128 v11, a[0:3] offset:0
    ds_write_b128 v11, a[4:7] offset:1024
    ds_read_b64_tr_b16 a[0:1], v9 offset:0
    ds_read_b64_tr_b16 a[2:3], v9 offset:1024
    ds_read_b64_tr_b16 a[4:5], v10 offset:0
    ds_read_b64_tr_b16 a[6:7], v10 offset:1024
    ds_write_b128 v11, a[8:11] offset:2048
    ds_write_b128 v11, a[12:15] offset:3072
    ds_read_b64_tr_b16 a[8:9], v9 offset:2048
    ds_read_b64_tr_b16 a[10:11], v9 offset:3072
    ds_read_b64_tr_b16 a[12:13], v10 offset:2048
    ds_read_b64_tr_b16 a[14:15], v10 offset:3072
    ds_write_b128 v11, a[16:19] offset:4096
    ds_write_b128 v11, a[20:23] offset:5120
    ds_read_b64_tr_b16 a[16:17], v9 offset:4096
    ds_read_b64_tr_b16 a[18:19], v9 offset:5120
    ds_read_b64_tr_b16 a[20:21], v10 offset:4096
    ds_read_b64_tr_b16 a[22:23], v10 offset:5120
    ds_write_b128 v11, a[24:27] offset:6144
    ds_write_b128 v11, a[28:31] offset:7168
    ds_read_b64_tr_b16 a[24:25], v9 offset:6144
    ds_read_b64_tr_b16 a[26:27], v9 offset:7168
    ds_read_b64_tr_b16 a[28:29], v10 offset:6144
    ds_read_b64_tr_b16 a[30:31], v10 offset:7168
    s_cmp_lg_u32 s4, 0
    s_cbranch_scc1 L_sequential_preLN__linear_kernel_hedgehog__glu_gated_geglu__prompt_kernel_15
    s_mov_b64 s[30:31], exec
    s_mov_b64 exec, 1
    s_mov_b32 s34, 0
L_sequential_preLN__linear_kernel_hedgehog__glu_gated_geglu__prompt_kernel_16:
    buffer_load_dword v7, off, s[72:75], s93 offset:0 sc1
    s_waitcnt vmcnt(0)
    v_readfirstlane_b32 s9, v7
    s_nop 0
    s_cmp_ge_u32 s9, 16
    s_cbranch_scc1 L_sequential_preLN__linear_kernel_hedgehog__glu_gated_geglu__prompt_kernel_17
    s_sleep 1
    s_add_u32 s34, s34, 1
    s_cmp_lt_u32 s34, 4194304
    s_cbranch_scc1 L_sequential_preLN__linear_kernel_hedgehog__glu_gated_geglu__prompt_kernel_16
L_sequential_preLN__linear_kernel_hedgehog__glu_gated_geglu__prompt_kernel_17:
    s_mov_b64 exec, s[30:31]
L_sequential_preLN__linear_kernel_hedgehog__glu_gated_geglu__prompt_kernel_15:
    s_waitcnt lgkmcnt(0)
    s_barrier
    buffer_load_dwordx4 v[32:35], v2, s[72:75], s13 offen offset:0 sc1
    buffer_load_dwordx4 v[36:39], v2, s[72:75], s14 offen offset:0 sc1
    buffer_load_dwordx4 v[40:43], v2, s[72:75], s13 offen offset:1024 sc1
    buffer_load_dwordx4 v[44:47], v2, s[72:75], s14 offen offset:1024 sc1
    buffer_load_dwordx4 v[48:51], v2, s[72:75], s13 offen offset:2048 sc1
    buffer_load_dwordx4 v[52:55], v2, s[72:75], s14 offen offset:2048 sc1
    buffer_load_dwordx4 v[56:59], v2, s[72:75], s13 offen offset:3072 sc1
    buffer_load_dwordx4 v[60:63], v2, s[72:75], s14 offen offset:3072 sc1
    s_add_u32 s13, s13, 4096
    s_add_u32 s14, s14, 4096
    buffer_load_dwordx4 v[64:67], v2, s[72:75], s13 offen offset:0 sc1
    buffer_load_dwordx4 v[68:71], v2, s[72:75], s14 offen offset:0 sc1
    buffer_load_dwordx4 v[72:75], v2, s[72:75], s13 offen offset:1024 sc1
    buffer_load_dwordx4 v[76:79], v2, s[72:75], s14 offen offset:1024 sc1
    buffer_load_dwordx4 v[80:83], v2, s[72:75], s13 offen offset:2048 sc1
    buffer_load_dwordx4 v[84:87], v2, s[72:75], s14 offen offset:2048 sc1
    buffer_load_dwordx4 v[88:91], v2, s[72:75], s13 offen offset:3072 sc1
    buffer_load_dwordx4 v[92:95], v2, s[72:75], s14 offen offset:3072 sc1
    s_waitcnt vmcnt(41)
    v_add_f32 v160, v160, v162
    s_waitcnt vmcnt(40)
    v_add_f32 v161, v161, v163
    s_waitcnt vmcnt(39)
    v_add_f32 v160, v160, v164
    s_waitcnt vmcnt(38)
    v_add_f32 v161, v161, v165
    s_waitcnt vmcnt(37)
    v_add_f32 v160, v160, v166
    s_waitcnt vmcnt(36)
    v_add_f32 v161, v161, v167
    s_waitcnt vmcnt(35)
    v_add_f32 v160, v160, v168
    s_waitcnt vmcnt(34)
    v_add_f32 v161, v161, v169
    s_waitcnt vmcnt(33)
    v_add_f32 v160, v160, v170
    s_waitcnt vmcnt(32)
    v_add_f32 v161, v161, v171
    s_waitcnt vmcnt(31)
    v_add_f32 v160, v160, v172
    s_waitcnt vmcnt(30)
    v_add_f32 v161, v161, v173
    s_waitcnt vmcnt(29)
    v_add_f32 v160, v160, v174
    s_waitcnt vmcnt(28)
    v_add_f32 v161, v161, v175
    s_waitcnt vmcnt(27)
    v_add_f32 v160, v160, v176
    s_waitcnt vmcnt(26)
    v_add_f32 v161, v161, v177
    s_waitcnt vmcnt(25)
    v_add_f32 v160, v160, v178
    s_waitcnt vmcnt(24)
    v_add_f32 v161, v161, v179
    s_waitcnt vmcnt(23)
    v_add_f32 v160, v160, v180
    s_waitcnt vmcnt(22)
    v_add_f32 v161, v161, v181
    s_waitcnt vmcnt(21)
    v_add_f32 v160, v160, v182
    s_waitcnt vmcnt(20)
    v_add_f32 v161, v161, v183
    s_waitcnt vmcnt(19)
    v_add_f32 v160, v160, v184
    s_waitcnt vmcnt(18)
    v_add_f32 v161, v161, v185
    s_waitcnt vmcnt(17)
    v_add_f32 v160, v160, v186
    s_waitcnt vmcnt(16)
    v_add_f32 v161, v161, v187
    v_add_f32 v160, v160, v161
    v_cvt_pk_bf16_f32 v162, v160, v160
    v_lshlrev_b32 v7, 16, v162
    v_sub_f32 v160, v160, v7
    v_cvt_pk_bf16_f32 v163, v160, v160
    v_lshlrev_b32 v7, 16, v163
    v_sub_f32 v160, v160, v7
    v_and_b32 v162, 0xffff, v162
    v_or_b32 v162, v162, v7
    v_cvt_pk_bf16_f32 v163, v160, v5
    v_lshlrev_b32 v9, 3, v0
    v_add_u32 v9, 156672, v9
    v_cmp_gt_u32 vcc, 224, v0
    s_nop 0
    s_and_saveexec_b64 s[30:31], vcc
    ds_write_b64 v9, v[162:163]
    s_mov_b64 exec, s[30:31]
    s_waitcnt vmcnt(14)
    v_mfma_f32_32x32x16_bf16 v[96:111], a[160:163], v[32:35], 0
    s_add_u32 s35, s36, 61440
    s_add_u32 m0, s37, 61440
    s_nop 0
    buffer_load_dwordx4 v2, s[72:75], s35 offen offset:0 sc1 lds
    buffer_load_dwordx4 v2, s[72:75], s35 offen offset:1024 sc1 lds
    buffer_load_dwordx4 v2, s[72:75], s35 offen offset:2048 sc1 lds
    v_mfma_f32_32x32x16_bf16 v[112:127], a[160:163], v[36:39], 0
    v_mfma_f32_32x32x16_bf16 v[128:143], a[164:167], v[32:35], 0
    v_mfma_f32_32x32x16_bf16 v[144:159], a[164:167], v[36:39], 0
    s_add_u32 s35, s84, 121856
    buffer_load_dwordx4 a[68:71], v22, s[60:63], s35 offen
    s_waitcnt vmcnt(16)
    v_mfma_f32_32x32x16_bf16 v[96:111], a[168:171], v[40:43], v[96:111]
    v_mfma_f32_32x32x16_bf16 v[112:127], a[168:171], v[44:47], v[112:127]
    s_add_u32 s35, s84, 129024
    buffer_load_dwordx4 a[72:75], v22, s[60:63], s35 offen
    v_mfma_f32_32x32x16_bf16 v[128:143], a[172:175], v[40:43], v[128:143]
    v_mfma_f32_32x32x16_bf16 v[144:159], a[172:175], v[44:47], v[144:159]
    s_waitcnt vmcnt(15)
    v_mfma_f32_32x32x16_bf16 v[96:111], a[176:179], v[48:51], v[96:111]
    s_add_u32 s35, s84, 136192
    buffer_load_dwordx4 a[76:79], v22, s[60:63], s35 offen
    v_mfma_f32_32x32x16_bf16 v[112:127], a[176:179], v[52:55], v[112:127]
    v_mfma_f32_32x32x16_bf16 v[128:143], a[180:183], v[48:51], v[128:143]
    v_mfma_f32_32x32x16_bf16 v[144:159], a[180:183], v[52:55], v[144:159]
    s_add_u32 s35, s84, 143360
    buffer_load_dwordx4 a[80:83], v22, s[60:63], s35 offen
    s_waitcnt vmcnt(15)
    v_mfma_f32_32x32x16_bf16 v[96:111], a[184:187], v[56:59], v[96:111]
    v_mfma_f32_32x32x16_bf16 v[112:127], a[184:187], v[60:63], v[112:127]
    v_mfma_f32_32x32x16_bf16 v[128:143], a[188:191], v[56:59], v[128:143]
    s_add_u32 s35, s84, 150528
    buffer_load_dwordx4 a[84:87], v22, s[60:63], s35 offen
    v_mfma_f32_32x32x16_bf16 v[144:159], a[188:191], v[60:63], v[144:159]
    s_waitcnt vmcnt(14)
    v_mfma_f32_32x32x16_bf16 v[96:111], a[192:195], v[64:67], v[96:111]
    v_mfma_f32_32x32x16_bf16 v[112:127], a[192:195], v[68:71], v[112:127]
    s_add_u32 s35, s84, 157696
    buffer_load_dwordx4 a[88:91], v22, s[60:63], s35 offen
    v_mfma_f32_32x32x16_bf16 v[128:143], a[196:199], v[64:67], v[128:143]
    v_mfma_f32_32x32x16_bf16 v[144:159], a[196:199], v[68:71], v[144:159]
    s_add_u32 s35, s84, 164864
    buffer_load_dwordx4 a[92:95], v22, s[60:63], s35 offen
    s_waitcnt vmcnt(14)
    v_mfma_f32_32x32x16_bf16 v[96:111], a[200:203], v[72:75], v[96:111]
    v_mfma_f32_32x32x16_bf16 v[112:127], a[200:203], v[76:79], v[112:127]
    v_mfma_f32_32x32x16_bf16 v[128:143], a[204:207], v[72:75], v[128:143]
    s_add_u32 s35, s84, 172032
    buffer_load_dwordx4 a[96:99], v22, s[60:63], s35 offen
    v_mfma_f32_32x32x16_bf16 v[144:159], a[204:207], v[76:79], v[144:159]
    s_waitcnt vmcnt(13)
    v_mfma_f32_32x32x16_bf16 v[96:111], a[208:211], v[80:83], v[96:111]
    v_mfma_f32_32x32x16_bf16 v[112:127], a[208:211], v[84:87], v[112:127]
    s_add_u32 s35, s84, 179200
    buffer_load_dwordx4 a[100:103], v22, s[60:63], s35 offen
    v_mfma_f32_32x32x16_bf16 v[128:143], a[212:215], v[80:83], v[128:143]
    v_mfma_f32_32x32x16_bf16 v[144:159], a[212:215], v[84:87], v[144:159]
    s_waitcnt vmcnt(12)
    v_mfma_f32_32x32x16_bf16 v[112:127], a[216:219], v[92:95], v[112:127]
    s_add_u32 s35, s84, 186368
    buffer_load_dwordx4 a[104:107], v22, s[60:63], s35 offen
    v_mfma_f32_32x32x16_bf16 v[128:143], a[220:223], v[88:91], v[128:143]
    v_mfma_f32_32x32x16_bf16 v[144:159], a[220:223], v[92:95], v[144:159]
    v_mfma_f32_32x32x16_bf16 v[96:111], a[216:219], v[88:91], v[96:111]
    s_add_u32 s35, s84, 193536
    buffer_load_dwordx4 a[108:111], v22, s[60:63], s35 offen
    s_xor_b32 s7, s4, 1
    s_mul_i32 s7, s7, 12288
    s_add_u32 s7, s7, 86016
    v_add_u32 v7, s7, v2
    s_nop 0
    ds_write_b128 v7, v[112:115] offset:0
    ds_write_b128 v7, v[116:119] offset:1024
    ds_write_b128 v7, v[120:123] offset:2048
    ds_write_b128 v7, v[124:127] offset:3072
    s_xor_b32 s7, s4, 2
    s_mul_i32 s7, s7, 12288
    s_add_u32 s7, s7, 90112
    v_add_u32 v7, s7, v2
    ds_write_b128 v7, v[128:131] offset:0
    ds_write_b128 v7, v[132:135] offset:1024
    ds_write_b128 v7, v[136:139] offset:2048
    ds_write_b128 v7, v[140:143] offset:3072
    s_xor_b32 s7, s4, 3
    s_mul_i32 s7, s7, 12288
    s_add_u32 s7, s7, 94208
    v_add_u32 v7, s7, v2
    ds_write_b128 v7, v[144:147] offset:0
    ds_write_b128 v7, v[148:151] offset:1024
    ds_write_b128 v7, v[152:155] offset:2048
    ds_write_b128 v7, v[156:159] offset:3072
    s_mul_i32 s7, s4, 12288
    s_add_u32 s7, s7, 86016
    v_add_u32 v7, s7, v2
    s_add_u32 s35, s84, 200704
    buffer_load_dwordx4 a[112:115], v22, s[60:63], s35 offen
    s_waitcnt lgkmcnt(0)
    s_barrier
    ds_read_b128 v[32:35], v7 offset:0
    ds_read_b128 v[36:39], v7 offset:1024
    ds_read_b128 v[40:43], v7 offset:2048
    ds_read_b128 v[44:47], v7 offset:3072
    ds_read_b128 v[48:51], v7 offset:4096
    ds_read_b128 v[52:55], v7 offset:5120
    ds_read_b128 v[56:59], v7 offset:6144
    ds_read_b128 v[60:63], v7 offset:7168
    ds_read_b128 v[64:67], v7 offset:8192
    ds_read_b128 v[68:71], v7 offset:9216
    ds_read_b128 v[72:75], v7 offset:10240
    ds_read_b128 v[76:79], v7 offset:11264
    s_waitcnt lgkmcnt(11)
    v_pk_add_f32 v[96:97], v[96:97], v[32:33]
    v_pk_add_f32 v[98:99], v[98:99], v[34:35]
    s_waitcnt lgkmcnt(10)
    v_pk_add_f32 v[100:101], v[100:101], v[36:37]
    v_pk_add_f32 v[102:103], v[102:103], v[38:39]
    s_waitcnt lgkmcnt(9)
    v_pk_add_f32 v[104:105], v[104:105], v[40:41]
    v_pk_add_f32 v[106:107], v[106:107], v[42:43]
    s_waitcnt lgkmcnt(8)
    v_pk_add_f32 v[108:109], v[108:109], v[44:45]
    v_pk_add_f32 v[110:111], v[110:111], v[46:47]
    s_add_u32 s35, s84, 207872
    buffer_load_dwordx4 a[116:119], v22, s[60:63], s35 offen
    s_waitcnt lgkmcnt(7)
    v_pk_add_f32 v[96:97], v[96:97], v[48:49]
    v_pk_add_f32 v[98:99], v[98:99], v[50:51]
    s_waitcnt lgkmcnt(6)
    v_pk_add_f32 v[100:101], v[100:101], v[52:53]
    v_pk_add_f32 v[102:103], v[102:103], v[54:55]
    s_waitcnt lgkmcnt(5)
    v_pk_add_f32 v[104:105], v[104:105], v[56:57]
    v_pk_add_f32 v[106:107], v[106:107], v[58:59]
    s_waitcnt lgkmcnt(4)
    v_pk_add_f32 v[108:109], v[108:109], v[60:61]
    v_pk_add_f32 v[110:111], v[110:111], v[62:63]
    s_waitcnt lgkmcnt(3)
    v_pk_add_f32 v[96:97], v[96:97], v[64:65]
    v_pk_add_f32 v[98:99], v[98:99], v[66:67]
    s_waitcnt lgkmcnt(2)
    v_pk_add_f32 v[100:101], v[100:101], v[68:69]
    v_pk_add_f32 v[102:103], v[102:103], v[70:71]
    s_waitcnt lgkmcnt(1)
    v_pk_add_f32 v[104:105], v[104:105], v[72:73]
    v_pk_add_f32 v[106:107], v[106:107], v[74:75]
    s_waitcnt lgkmcnt(0)
    v_pk_add_f32 v[108:109], v[108:109], v[76:77]
    v_pk_add_f32 v[110:111], v[110:111], v[78:79]
    v_cvt_pk_bf16_f32 v32, v96, v97
    v_cvt_pk_bf16_f32 v33, v98, v99
    v_cvt_pk_bf16_f32 v34, v100, v101
    v_cvt_pk_bf16_f32 v35, v102, v103
    v_cvt_pk_bf16_f32 v36, v104, v105
    v_cvt_pk_bf16_f32 v37, v106, v107
    v_cvt_pk_bf16_f32 v38, v108, v109
    v_cvt_pk_bf16_f32 v39, v110, v111
    v_lshlrev_b32 v96, 16, v32
    v_and_b32 v97, 0xffff0000, v32
    v_lshlrev_b32 v98, 16, v33
    v_and_b32 v99, 0xffff0000, v33
    v_lshlrev_b32 v100, 16, v34
    v_and_b32 v101, 0xffff0000, v34
    v_lshlrev_b32 v102, 16, v35
    v_and_b32 v103, 0xffff0000, v35
    v_lshlrev_b32 v104, 16, v36
    v_and_b32 v105, 0xffff0000, v36
    v_lshlrev_b32 v106, 16, v37
    v_and_b32 v107, 0xffff0000, v37
    v_lshlrev_b32 v108, 16, v38
    v_and_b32 v109, 0xffff0000, v38
    v_lshlrev_b32 v110, 16, v39
    v_and_b32 v111, 0xffff0000, v39
    v_dot2c_f32_bf16 v96, s18, v24
    v_dot2c_f32_bf16 v97, s19, v24
    v_dot2c_f32_bf16 v98, s18, v25
    v_dot2c_f32_bf16 v99, s19, v25
    v_dot2c_f32_bf16 v100, s18, v26
    v_dot2c_f32_bf16 v101, s19, v26
    v_dot2c_f32_bf16 v102, s18, v27
    v_dot2c_f32_bf16 v103, s19, v27
    v_dot2c_f32_bf16 v104, s18, v28
    v_dot2c_f32_bf16 v105, s19, v28
    v_dot2c_f32_bf16 v106, s18, v29
    v_dot2c_f32_bf16 v107, s19, v29
    v_dot2c_f32_bf16 v108, s18, v30
    v_dot2c_f32_bf16 v109, s19, v30
    v_dot2c_f32_bf16 v110, s18, v31
    v_dot2c_f32_bf16 v111, s19, v31
    v_cvt_pk_bf16_f32 v24, v96, v97
    v_cvt_pk_bf16_f32 v25, v98, v99
    v_cvt_pk_bf16_f32 v26, v100, v101
    v_cvt_pk_bf16_f32 v27, v102, v103
    v_cvt_pk_bf16_f32 v28, v104, v105
    v_cvt_pk_bf16_f32 v29, v106, v107
    v_cvt_pk_bf16_f32 v30, v108, v109
    v_cvt_pk_bf16_f32 v31, v110, v111
    s_mul_i32 s9, s28, 28
    s_lshl_b32 s7, s27, 1
    s_add_u32 s9, s9, s7
    s_lshl_b32 s9, s9, 10
    s_add_u32 s9, s9, 0x1300000
    s_lshl_b32 s13, s27, 14
    s_lshl_b32 s7, s28, 8
    s_add_u32 s13, s13, s7
    s_add_u32 s13, s13, 0x1500000
    s_cmp_lt_u32 s89, 14
    s_cselect_b32 s9, s9, 0x40000000
    s_cselect_b32 s13, s13, 0x40000000
    buffer_store_dwordx4 v[24:27], v2, s[72:75], s9 offen offset:0 sc1
    buffer_store_dwordx4 v[28:31], v2, s[72:75], s9 offen offset:1024 sc1
    v_mov_b32 v96, 0
    v_mov_b32 v97, 0
    v_dot2c_f32_bf16 v96, s17, v24
    v_dot2c_f32_bf16 v97, v24, v24
    v_dot2c_f32_bf16 v96, s17, v25
    v_dot2c_f32_bf16 v97, v25, v25
    v_dot2c_f32_bf16 v96, s17, v26
    v_dot2c_f32_bf16 v97, v26, v26
    v_dot2c_f32_bf16 v96, s17, v27
    v_dot2c_f32_bf16 v97, v27, v27
    v_dot2c_f32_bf16 v96, s17, v28
    v_dot2c_f32_bf16 v97, v28, v28
    v_dot2c_f32_bf16 v96, s17, v29
    v_dot2c_f32_bf16 v97, v29, v29
    v_dot2c_f32_bf16 v96, s17, v30
    v_dot2c_f32_bf16 v97, v30, v30
    v_dot2c_f32_bf16 v96, s17, v31
    v_dot2c_f32_bf16 v97, v31, v31
    s_nop 1
    v_mov_b32 v7, v96
    s_nop 1
    v_permlane32_swap_b32 v96, v7
    v_add_f32 v96, v96, v7
    v_mov_b32 v8, v97
    s_nop 1
    v_permlane32_swap_b32 v97, v8
    v_add_f32 v97, v97, v8
    v_lshlrev_b32 v7, 3, v3
    v_mov_b32 v8, 0x40000000
    v_cndmask_b32 v7, v8, v7, s[32:33]
    buffer_store_dwordx2 v[96:97], v7, s[72:75], s13 offen sc1
    s_waitcnt vmcnt(0)
    s_barrier
    s_cmp_lg_u32 s4, 0
    s_cbranch_scc1 L_sequential_preLN__linear_kernel_hedgehog__glu_gated_geglu__prompt_kernel_18
    s_mov_b64 s[30:31], exec
    s_mov_b64 exec, 1
    v_mov_b32 v7, 1
    buffer_atomic_add v7, off, s[72:75], s93 offset:4 sc1
    s_mov_b64 exec, s[30:31]
L_sequential_preLN__linear_kernel_hedgehog__glu_gated_geglu__prompt_kernel_18:
    s_add_u32 s35, s36, 86016
    s_add_u32 m0, s37, 86016
    s_nop 0
    buffer_load_dwordx4 v2, s[72:75], s35 offen offset:0 sc1 lds
    buffer_load_dwordx4 v2, s[72:75], s35 offen offset:1024 sc1 lds
    buffer_load_dwordx4 v2, s[72:75], s35 offen offset:2048 sc1 lds
    buffer_load_dwordx4 v2, s[72:75], s35 offen offset:3072 sc1 lds
    s_add_u32 s35, s36, 90112
    s_add_u32 m0, s37, 90112
    s_nop 0
    buffer_load_dwordx4 v2, s[72:75], s35 offen offset:0 sc1 lds
    buffer_load_dwordx4 v2, s[72:75], s35 offen offset:1024 sc1 lds
    buffer_load_dwordx4 v2, s[72:75], s35 offen offset:2048 sc1 lds
    s_add_u32 s35, s36, 114688
    s_add_u32 m0, s37, 114688
    s_nop 0
    buffer_load_dwordx4 v2, s[72:75], s35 offen offset:0 sc1 lds
    buffer_load_dwordx4 v2, s[72:75], s35 offen offset:1024 sc1 lds
    buffer_load_dwordx4 v2, s[72:75], s35 offen offset:2048 sc1 lds
    buffer_load_dwordx4 v2, s[72:75], s35 offen offset:3072 sc1 lds
    s_add_u32 s35, s36, 118784
    s_add_u32 m0, s37, 118784
    s_nop 0
    buffer_load_dwordx4 v2, s[72:75], s35 offen offset:0 sc1 lds
    buffer_load_dwordx4 v2, s[72:75], s35 offen offset:1024 sc1 lds
    buffer_load_dwordx4 v2, s[72:75], s35 offen offset:2048 sc1 lds
    v_add_u32 v19, 0, v2
    v_add_u32 v20, 57344, v2
    v_add_u32 v21, 114688, v2
    v_lshlrev_b32 v7, 3, v3
    v_add_u32 v10, 156672, v7
    v_accvgpr_write_b32 a162, 0
    v_accvgpr_write_b32 a163, 0
    ds_read_b64 a[160:161], v10 offset:0
    v_accvgpr_write_b32 a166, 0
    v_accvgpr_write_b32 a167, 0
    ds_read_b64 a[164:165], v10 offset:256
    v_accvgpr_write_b32 a170, 0
    v_accvgpr_write_b32 a171, 0
    ds_read_b64 a[168:169], v10 offset:512
    v_accvgpr_write_b32 a174, 0
    v_accvgpr_write_b32 a175, 0
    ds_read_b64 a[172:173], v10 offset:768
    v_accvgpr_write_b32 a178, 0
    v_accvgpr_write_b32 a179, 0
    ds_read_b64 a[176:177], v10 offset:1024
    v_accvgpr_write_b32 a182, 0
    v_accvgpr_write_b32 a183, 0
    ds_read_b64 a[180:181], v10 offset:1280
    v_accvgpr_write_b32 a186, 0
    v_accvgpr_write_b32 a187, 0
    ds_read_b64 a[184:185], v10 offset:1536
    v_accvgpr_write_b32 a190, 0
    v_accvgpr_write_b32 a191, 0
    v_mul_u32_u24 v9, 114688, v4
    v_lshl_add_u32 v9, v3, 3, v9
    s_lshl_b32 s13, s92, 8
    s_add_u32 s13, s13, 0x1500000
    s_mul_i32 s14, s92, 28672
    s_add_u32 s14, s14, 0x1300000
    s_mul_i32 s12, s92, 112
    s_mul_i32 s7, s91, 7
    s_add_u32 s12, s12, s7
    s_lshl_b32 s12, s12, 10
    s_add_u32 s12, s12, 0x1620000
    v_mov_b32 v12, v9
    s_mul_i32 s7, s4, 2048
    s_add_u32 s8, s7, 143360
    v_bfe_u32 v7, v1, 2, 2
    v_lshlrev_b32 v9, 7, v7
    v_and_b32 v8, 3, v1
    v_lshl_add_u32 v9, v8, 3, v9
    v_bfe_u32 v8, v1, 4, 1
    v_lshl_add_u32 v9, v8, 5, v9
    v_bfe_u32 v8, v1, 3, 1
    v_lshlrev_b32 v8, 6, v8
    v_xor_b32 v9, v9, v8
    v_lshl_add_u32 v9, v4, 9, v9
    s_lshr_b32 s7, s4, 1
    s_lshl_b32 s7, s7, 6
    v_xor_b32 v9, s7, v9
    v_xor_b32 v10, 64, v9
    v_add_u32 v9, s8, v9
    v_add_u32 v10, s8, v10
    v_add_u32 v11, s8, v2
    ds_write_b128 v11, a[32:35] offset:0
    ds_write_b128 v11, a[36:39] offset:1024
    ds_read_b64_tr_b16 a[32:33], v9 offset:0
    ds_read_b64_tr_b16 a[34:35], v9 offset:1024
    ds_read_b64_tr_b16 a[36:37], v10 offset:0
    ds_read_b64_tr_b16 a[38:39], v10 offset:1024
    ds_write_b128 v11, a[40:43] offset:0
    ds_write_b128 v11, a[44:47] offset:1024
    ds_read_b64_tr_b16 a[40:41], v9 offset:0
    ds_read_b64_tr_b16 a[42:43], v9 offset:1024
    ds_read_b64_tr_b16 a[44:45], v10 offset:0
    ds_read_b64_tr_b16 a[46:47], v10 offset:1024
    ds_write_b128 v11, a[48:51] offset:0
    ds_write_b128 v11, a[52:55] offset:1024
    ds_read_b64_tr_b16 a[48:49], v9 offset:0
    ds_read_b64_tr_b16 a[50:51], v9 offset:1024
    ds_read_b64_tr_b16 a[52:53], v10 offset:0
    ds_read_b64_tr_b16 a[54:55], v10 offset:1024
    ds_write_b128 v11, a[56:59] offset:0
    ds_write_b128 v11, a[60:63] offset:1024
    ds_read_b64_tr_b16 a[56:57], v9 offset:0
    ds_read_b64_tr_b16 a[58:59], v9 offset:1024
    ds_read_b64_tr_b16 a[60:61], v10 offset:0
    ds_read_b64_tr_b16 a[62:63], v10 offset:1024
    v_mov_b32 v9, v12
    s_cmp_lg_u32 s4, 0
    s_cbranch_scc1 L_sequential_preLN__linear_kernel_hedgehog__glu_gated_geglu__prompt_kernel_19
    s_mov_b64 s[30:31], exec
    s_mov_b64 exec, 1
    s_mov_b32 s34, 0
L_sequential_preLN__linear_kernel_hedgehog__glu_gated_geglu__prompt_kernel_20:
    buffer_load_dword v7, off, s[72:75], s94 offset:4 sc1
    s_waitcnt vmcnt(0)
    v_readfirstlane_b32 s9, v7
    s_nop 0
    s_cmp_ge_u32 s9, 16
    s_cbranch_scc1 L_sequential_preLN__linear_kernel_hedgehog__glu_gated_geglu__prompt_kernel_21
    s_sleep 1
    s_add_u32 s34, s34, 1
    s_cmp_lt_u32 s34, 4194304
    s_cbranch_scc1 L_sequential_preLN__linear_kernel_hedgehog__glu_gated_geglu__prompt_kernel_20
L_sequential_preLN__linear_kernel_hedgehog__glu_gated_geglu__prompt_kernel_21:
    s_mov_b64 exec, s[30:31]
L_sequential_preLN__linear_kernel_hedgehog__glu_gated_geglu__prompt_kernel_19:
    s_waitcnt lgkmcnt(0)
    s_barrier
    s_add_u32 s35, s14, 0
    buffer_load_dwordx4 v[32:35], v2, s[72:75], s35 offen sc1
    s_add_u32 s35, s14, 1024
    buffer_load_dwordx4 v[36:39], v2, s[72:75], s35 offen sc1
    s_add_u32 s35, s14, 2048
    buffer_load_dwordx4 v[40:43], v2, s[72:75], s35 offen sc1
    s_add_u32 s35, s14, 3072
    buffer_load_dwordx4 v[44:47], v2, s[72:75], s35 offen sc1
    s_add_u32 s35, s14, 4096
    buffer_load_dwordx4 v[48:51], v2, s[72:75], s35 offen sc1
    s_add_u32 s35, s14, 5120
    buffer_load_dwordx4 v[52:55], v2, s[72:75], s35 offen sc1
    ds_read_b128 a[224:227], v19 offset:0
    ds_read_b128 a[228:231], v19 offset:28672
    ds_read_b128 a[232:235], v20 offset:0
    ds_read_b128 a[236:239], v19 offset:1024
    ds_read_b128 a[240:243], v19 offset:29696
    ds_read_b128 a[244:247], v20 offset:1024
    s_waitcnt lgkmcnt(4)
    s_waitcnt vmcnt(5)
    v_mfma_f32_32x32x16_bf16 v[144:159], a[224:227], v[32:35], 0
    ds_read_b128 a[224:227], v19 offset:2048
    v_mfma_f32_32x32x16_bf16 v[160:175], a[228:231], v[32:35], 0
    s_add_u32 s35, s14, 6144
    buffer_load_dwordx4 v[56:59], v2, s[72:75], s35 offen sc1
    ds_read_b128 a[228:231], v19 offset:30720
    s_waitcnt lgkmcnt(4)
    v_mfma_f32_32x32x16_bf16 v[176:191], a[232:235], v[32:35], 0
    ds_read_b128 a[232:235], v20 offset:2048
    s_waitcnt vmcnt(5)
    v_mfma_f32_32x32x16_bf16 v[144:159], a[236:239], v[36:39], v[144:159]
    s_add_u32 s35, s14, 7168
    buffer_load_dwordx4 v[60:63], v2, s[72:75], s35 offen sc1
    ds_read_b128 a[236:239], v19 offset:3072
    s_waitcnt lgkmcnt(4)
    v_mfma_f32_32x32x16_bf16 v[160:175], a[240:243], v[36:39], v[160:175]
    ds_read_b128 a[240:243], v19 offset:31744
    v_mfma_f32_32x32x16_bf16 v[176:191], a[244:247], v[36:39], v[176:191]
    s_add_u32 s35, s14, 8192
    buffer_load_dwordx4 v[64:67], v2, s[72:75], s35 offen sc1
    ds_read_b128 a[244:247], v20 offset:3072
    s_waitcnt lgkmcnt(4)
    s_waitcnt vmcnt(6)
    v_mfma_f32_32x32x16_bf16 v[144:159], a[224:227], v[40:43], v[144:159]
    ds_read_b128 a[224:227], v19 offset:4096
    v_mfma_f32_32x32x16_bf16 v[160:175], a[228:231], v[40:43], v[160:175]
    s_add_u32 s35, s14, 9216
    buffer_load_dwordx4 v[68:71], v2, s[72:75], s35 offen sc1
    ds_read_b128 a[228:231], v19 offset:32768
    s_waitcnt lgkmcnt(4)
    v_mfma_f32_32x32x16_bf16 v[176:191], a[232:235], v[40:43], v[176:191]
    ds_read_b128 a[232:235], v20 offset:4096
    s_waitcnt vmcnt(6)
    v_mfma_f32_32x32x16_bf16 v[144:159], a[236:239], v[44:47], v[144:159]
    s_add_u32 s35, s14, 10240
    buffer_load_dwordx4 v[72:75], v2, s[72:75], s35 offen sc1
    ds_read_b128 a[236:239], v19 offset:5120
    s_waitcnt lgkmcnt(4)
    v_mfma_f32_32x32x16_bf16 v[160:175], a[240:243], v[44:47], v[160:175]
    ds_read_b128 a[240:243], v19 offset:33792
    v_mfma_f32_32x32x16_bf16 v[176:191], a[244:247], v[44:47], v[176:191]
    s_add_u32 s35, s14, 11264
    buffer_load_dwordx4 v[76:79], v2, s[72:75], s35 offen sc1
    ds_read_b128 a[244:247], v20 offset:5120
    s_waitcnt lgkmcnt(4)
    s_waitcnt vmcnt(7)
    v_mfma_f32_32x32x16_bf16 v[144:159], a[224:227], v[48:51], v[144:159]
    ds_read_b128 a[224:227], v19 offset:6144
    v_mfma_f32_32x32x16_bf16 v[160:175], a[228:231], v[48:51], v[160:175]
    s_add_u32 s35, s14, 12288
    buffer_load_dwordx4 v[80:83], v2, s[72:75], s35 offen sc1
    ds_read_b128 a[228:231], v19 offset:34816
    s_waitcnt lgkmcnt(4)
    v_mfma_f32_32x32x16_bf16 v[176:191], a[232:235], v[48:51], v[176:191]
    s_add_u32 s35, s14, 13312
    buffer_load_dwordx4 v[84:87], v2, s[72:75], s35 offen sc1
    ds_read_b128 a[232:235], v20 offset:6144
    s_waitcnt vmcnt(8)
    v_mfma_f32_32x32x16_bf16 v[144:159], a[236:239], v[52:55], v[144:159]
    ds_read_b128 a[236:239], v19 offset:7168
    s_waitcnt lgkmcnt(4)
    v_mfma_f32_32x32x16_bf16 v[160:175], a[240:243], v[52:55], v[160:175]
    s_add_u32 s35, s14, 14336
    buffer_load_dwordx4 v[88:91], v2, s[72:75], s35 offen sc1
    ds_read_b128 a[240:243], v19 offset:35840
    v_mfma_f32_32x32x16_bf16 v[176:191], a[244:247], v[52:55], v[176:191]
    ds_read_b128 a[244:247], v20 offset:7168
    s_waitcnt lgkmcnt(4)
    s_waitcnt vmcnt(8)
    v_mfma_f32_32x32x16_bf16 v[144:159], a[224:227], v[56:59], v[144:159]
    s_add_u32 s35, s14, 15360
    buffer_load_dwordx4 v[92:95], v2, s[72:75], s35 offen sc1
    ds_read_b128 a[224:227], v19 offset:8192
    v_mfma_f32_32x32x16_bf16 v[160:175], a[228:231], v[56:59], v[160:175]
    ds_read_b128 a[228:231], v19 offset:36864
    s_waitcnt lgkmcnt(4)
    v_mfma_f32_32x32x16_bf16 v[176:191], a[232:235], v[56:59], v[176:191]
    s_add_u32 s35, s14, 16384
    buffer_load_dwordx4 v[96:99], v2, s[72:75], s35 offen sc1
    ds_read_b128 a[232:235], v20 offset:8192
    s_waitcnt vmcnt(9)
    v_mfma_f32_32x32x16_bf16 v[144:159], a[236:239], v[60:63], v[144:159]
    ds_read_b128 a[236:239], v19 offset:9216
    s_waitcnt lgkmcnt(4)
    v_mfma_f32_32x32x16_bf16 v[160:175], a[240:243], v[60:63], v[160:175]
    s_add_u32 s35, s14, 17408
    buffer_load_dwordx4 v[100:103], v2, s[72:75], s35 offen sc1
    ds_read_b128 a[240:243], v19 offset:37888
    v_mfma_f32_32x32x16_bf16 v[176:191], a[244:247], v[60:63], v[176:191]
    ds_read_b128 a[244:247], v20 offset:9216
    s_waitcnt lgkmcnt(4)
    s_waitcnt vmcnt(9)
    v_mfma_f32_32x32x16_bf16 v[144:159], a[224:227], v[64:67], v[144:159]
    s_add_u32 s35, s14, 18432
    buffer_load_dwordx4 v[104:107], v2, s[72:75], s35 offen sc1
    ds_read_b128 a[224:227], v19 offset:10240
    v_mfma_f32_32x32x16_bf16 v[160:175], a[228:231], v[64:67], v[160:175]
    ds_read_b128 a[228:231], v19 offset:38912
    s_waitcnt lgkmcnt(4)
    v_mfma_f32_32x32x16_bf16 v[176:191], a[232:235], v[64:67], v[176:191]
    s_add_u32 s35, s14, 19456
    buffer_load_dwordx4 v[108:111], v2, s[72:75], s35 offen sc1
    ds_read_b128 a[232:235], v20 offset:10240
    s_waitcnt vmcnt(10)
    v_mfma_f32_32x32x16_bf16 v[144:159], a[236:239], v[68:71], v[144:159]
    ds_read_b128 a[236:239], v19 offset:11264
    s_waitcnt lgkmcnt(4)
    v_mfma_f32_32x32x16_bf16 v[160:175], a[240:243], v[68:71], v[160:175]
    s_add_u32 s35, s14, 20480
    buffer_load_dwordx4 v[112:115], v2, s[72:75], s35 offen sc1
    ds_read_b128 a[240:243], v19 offset:39936
    v_mfma_f32_32x32x16_bf16 v[176:191], a[244:247], v[68:71], v[176:191]
    s_add_u32 s35, s14, 21504
    buffer_load_dwordx4 v[116:119], v2, s[72:75], s35 offen sc1
    ds_read_b128 a[244:247], v20 offset:11264
    s_waitcnt lgkmcnt(4)
    s_waitcnt vmcnt(11)
    v_mfma_f32_32x32x16_bf16 v[144:159], a[224:227], v[72:75], v[144:159]
    ds_read_b128 a[224:227], v19 offset:12288
    v_mfma_f32_32x32x16_bf16 v[160:175], a[228:231], v[72:75], v[160:175]
    s_add_u32 s35, s14, 22528
    buffer_load_dwordx4 v[120:123], v2, s[72:75], s35 offen sc1
    ds_read_b128 a[228:231], v19 offset:40960
    s_waitcnt lgkmcnt(4)
    v_mfma_f32_32x32x16_bf16 v[176:191], a[232:235], v[72:75], v[176:191]
    ds_read_b128 a[232:235], v20 offset:12288
    s_waitcnt vmcnt(11)
    v_mfma_f32_32x32x16_bf16 v[144:159], a[236:239], v[76:79], v[144:159]
    s_add_u32 s35, s14, 23552
    buffer_load_dwordx4 v[124:127], v2, s[72:75], s35 offen sc1
    ds_read_b128 a[236:239], v19 offset:13312
    s_waitcnt lgkmcnt(4)
    v_mfma_f32_32x32x16_bf16 v[160:175], a[240:243], v[76:79], v[160:175]
    ds_read_b128 a[240:243], v19 offset:41984
    v_mfma_f32_32x32x16_bf16 v[176:191], a[244:247], v[76:79], v[176:191]
    s_add_u32 s35, s14, 24576
    buffer_load_dwordx4 v[128:131], v2, s[72:75], s35 offen sc1
    ds_read_b128 a[244:247], v20 offset:13312
    s_waitcnt lgkmcnt(4)
    s_waitcnt vmcnt(12)
    v_mfma_f32_32x32x16_bf16 v[144:159], a[224:227], v[80:83], v[144:159]
    ds_read_b128 a[224:227], v19 offset:14336
    v_mfma_f32_32x32x16_bf16 v[160:175], a[228:231], v[80:83], v[160:175]
    s_add_u32 s35, s14, 25600
    buffer_load_dwordx4 v[132:135], v2, s[72:75], s35 offen sc1
    ds_read_b128 a[228:231], v19 offset:43008
    s_waitcnt lgkmcnt(4)
    v_mfma_f32_32x32x16_bf16 v[176:191], a[232:235], v[80:83], v[176:191]
    ds_read_b128 a[232:235], v20 offset:14336
    s_waitcnt vmcnt(12)
    v_mfma_f32_32x32x16_bf16 v[144:159], a[236:239], v[84:87], v[144:159]
    s_add_u32 s35, s14, 26624
    buffer_load_dwordx4 v[136:139], v2, s[72:75], s35 offen sc1
    ds_read_b128 a[236:239], v19 offset:15360
    s_waitcnt lgkmcnt(4)
    v_mfma_f32_32x32x16_bf16 v[160:175], a[240:243], v[84:87], v[160:175]
    ds_read_b128 a[240:243], v19 offset:44032
    v_mfma_f32_32x32x16_bf16 v[176:191], a[244:247], v[84:87], v[176:191]
    s_add_u32 s35, s14, 27648
    buffer_load_dwordx4 v[140:143], v2, s[72:75], s35 offen sc1
    ds_read_b128 a[244:247], v20 offset:15360
    s_waitcnt lgkmcnt(4)
    s_waitcnt vmcnt(13)
    v_mfma_f32_32x32x16_bf16 v[144:159], a[224:227], v[88:91], v[144:159]
    s_add_u32 s35, s13, 0
    buffer_load_dwordx2 a[192:193], v9, s[72:75], s35 offen sc1
    ds_read_b128 a[224:227], v19 offset:16384
    v_mfma_f32_32x32x16_bf16 v[160:175], a[228:231], v[88:91], v[160:175]
    s_add_u32 s35, s13, 16384
    buffer_load_dwordx2 a[194:195], v9, s[72:75], s35 offen sc1
    ds_read_b128 a[228:231], v19 offset:45056
    s_waitcnt lgkmcnt(4)
    v_mfma_f32_32x32x16_bf16 v[176:191], a[232:235], v[88:91], v[176:191]
    s_add_u32 s35, s13, 32768
    buffer_load_dwordx2 a[196:197], v9, s[72:75], s35 offen sc1
    ds_read_b128 a[232:235], v20 offset:16384
    s_waitcnt vmcnt(15)
    v_mfma_f32_32x32x16_bf16 v[144:159], a[236:239], v[92:95], v[144:159]
    s_add_u32 s35, s13, 49152
    buffer_load_dwordx2 a[198:199], v9, s[72:75], s35 offen sc1
    ds_read_b128 a[236:239], v19 offset:17408
    s_waitcnt lgkmcnt(4)
    v_mfma_f32_32x32x16_bf16 v[160:175], a[240:243], v[92:95], v[160:175]
    s_add_u32 s35, s13, 65536
    buffer_load_dwordx2 a[200:201], v9, s[72:75], s35 offen sc1
    ds_read_b128 a[240:243], v19 offset:46080
    v_mfma_f32_32x32x16_bf16 v[176:191], a[244:247], v[92:95], v[176:191]
    s_add_u32 s35, s13, 81920
    buffer_load_dwordx2 a[202:203], v9, s[72:75], s35 offen sc1
    ds_read_b128 a[244:247], v20 offset:17408
    s_waitcnt lgkmcnt(4)
    s_waitcnt vmcnt(17)
    v_mfma_f32_32x32x16_bf16 v[144:159], a[224:227], v[96:99], v[144:159]
    s_add_u32 s35, s13, 98304
    buffer_load_dwordx2 a[204:205], v9, s[72:75], s35 offen sc1
    ds_read_b128 a[224:227], v19 offset:18432
    v_mfma_f32_32x32x16_bf16 v[160:175], a[228:231], v[96:99], v[160:175]
    ds_read_b128 a[228:231], v19 offset:47104
    s_waitcnt lgkmcnt(4)
    v_mfma_f32_32x32x16_bf16 v[176:191], a[232:235], v[96:99], v[176:191]
    s_add_u32 s35, s84, 215040
    buffer_load_dwordx4 a[120:123], v22, s[60:63], s35 offen
    ds_read_b128 a[232:235], v20 offset:18432
    s_waitcnt vmcnt(18)
    v_mfma_f32_32x32x16_bf16 v[144:159], a[236:239], v[100:103], v[144:159]
    ds_read_b128 a[236:239], v19 offset:19456
    s_waitcnt lgkmcnt(4)
    v_mfma_f32_32x32x16_bf16 v[160:175], a[240:243], v[100:103], v[160:175]
    ds_read_b128 a[240:243], v19 offset:48128
    v_mfma_f32_32x32x16_bf16 v[176:191], a[244:247], v[100:103], v[176:191]
    s_add_u32 s35, s84, 222208
    buffer_load_dwordx4 a[124:127], v22, s[60:63], s35 offen
    ds_read_b128 a[244:247], v20 offset:19456
    s_waitcnt lgkmcnt(4)
    s_waitcnt vmcnt(18)
    v_mfma_f32_32x32x16_bf16 v[144:159], a[224:227], v[104:107], v[144:159]
    ds_read_b128 a[224:227], v19 offset:20480
    v_mfma_f32_32x32x16_bf16 v[160:175], a[228:231], v[104:107], v[160:175]
    ds_read_b128 a[228:231], v19 offset:49152
    s_waitcnt lgkmcnt(4)
    v_mfma_f32_32x32x16_bf16 v[176:191], a[232:235], v[104:107], v[176:191]
    s_add_u32 s35, s84, 229376
    buffer_load_dwordx4 a[128:131], v22, s[60:63], s35 offen
    ds_read_b128 a[232:235], v20 offset:20480
    s_waitcnt vmcnt(18)
    v_mfma_f32_32x32x16_bf16 v[144:159], a[236:239], v[108:111], v[144:159]
    ds_read_b128 a[236:239], v19 offset:21504
    s_waitcnt lgkmcnt(4)
    v_mfma_f32_32x32x16_bf16 v[160:175], a[240:243], v[108:111], v[160:175]
    ds_read_b128 a[240:243], v19 offset:50176
    v_mfma_f32_32x32x16_bf16 v[176:191], a[244:247], v[108:111], v[176:191]
    s_add_u32 s35, s84, 236544
    buffer_load_dwordx4 a[132:135], v22, s[60:63], s35 offen
    ds_read_b128 a[244:247], v20 offset:21504
    s_waitcnt lgkmcnt(4)
    s_waitcnt vmcnt(18)
    v_mfma_f32_32x32x16_bf16 v[144:159], a[224:227], v[112:115], v[144:159]
    ds_read_b128 a[224:227], v19 offset:22528
    v_mfma_f32_32x32x16_bf16 v[160:175], a[228:231], v[112:115], v[160:175]
    s_add_u32 s35, s84, 243712
    buffer_load_dwordx4 a[136:139], v22, s[60:63], s35 offen
    ds_read_b128 a[228:231], v19 offset:51200
    s_waitcnt lgkmcnt(4)
    v_mfma_f32_32x32x16_bf16 v[176:191], a[232:235], v[112:115], v[176:191]
    ds_read_b128 a[232:235], v20 offset:22528
    s_waitcnt vmcnt(18)
    v_mfma_f32_32x32x16_bf16 v[144:159], a[236:239], v[116:119], v[144:159]
    ds_read_b128 a[236:239], v19 offset:23552
    s_waitcnt lgkmcnt(4)
    v_mfma_f32_32x32x16_bf16 v[160:175], a[240:243], v[116:119], v[160:175]
    s_add_u32 s35, s84, 250880
    buffer_load_dwordx4 a[140:143], v22, s[60:63], s35 offen
    ds_read_b128 a[240:243], v19 offset:52224
    v_mfma_f32_32x32x16_bf16 v[176:191], a[244:247], v[116:119], v[176:191]
    ds_read_b128 a[244:247], v20 offset:23552
    s_waitcnt lgkmcnt(4)
    s_waitcnt vmcnt(18)
    v_mfma_f32_32x32x16_bf16 v[144:159], a[224:227], v[120:123], v[144:159]
    ds_read_b128 a[224:227], v19 offset:24576
    v_mfma_f32_32x32x16_bf16 v[160:175], a[228:231], v[120:123], v[160:175]
    s_add_u32 s35, s84, 258048
    buffer_load_dwordx4 a[144:147], v22, s[60:63], s35 offen
    ds_read_b128 a[228:231], v19 offset:53248
    s_waitcnt lgkmcnt(4)
    v_mfma_f32_32x32x16_bf16 v[176:191], a[232:235], v[120:123], v[176:191]
    ds_read_b128 a[232:235], v20 offset:24576
    s_waitcnt vmcnt(18)
    v_mfma_f32_32x32x16_bf16 v[144:159], a[236:239], v[124:127], v[144:159]
    ds_read_b128 a[236:239], v19 offset:25600
    s_waitcnt lgkmcnt(4)
    v_mfma_f32_32x32x16_bf16 v[160:175], a[240:243], v[124:127], v[160:175]
    s_add_u32 s35, s84, 265216
    buffer_load_dwordx4 a[148:151], v22, s[60:63], s35 offen
    ds_read_b128 a[240:243], v19 offset:54272
    v_mfma_f32_32x32x16_bf16 v[176:191], a[244:247], v[124:127], v[176:191]
    ds_read_b128 a[244:247], v20 offset:25600
    s_waitcnt lgkmcnt(4)
    s_waitcnt vmcnt(18)
    v_mfma_f32_32x32x16_bf16 v[144:159], a[224:227], v[128:131], v[144:159]
    ds_read_b128 a[224:227], v19 offset:26624
    s_waitcnt vmcnt(14)
    v_accvgpr_read_b32 v9, a192
    v_accvgpr_read_b32 v10, a193
    s_waitcnt vmcnt(13)
    v_accvgpr_read_b32 v7, a194
    v_accvgpr_read_b32 v8, a195
    v_add_f32 v9, v9, v7
    v_add_f32 v10, v10, v8
    s_waitcnt vmcnt(12)
    v_accvgpr_read_b32 v7, a196
    v_accvgpr_read_b32 v8, a197
    v_add_f32 v9, v9, v7
    v_add_f32 v10, v10, v8
    s_waitcnt vmcnt(11)
    v_accvgpr_read_b32 v7, a198
    v_accvgpr_read_b32 v8, a199
    v_add_f32 v9, v9, v7
    v_add_f32 v10, v10, v8
    s_waitcnt vmcnt(10)
    v_accvgpr_read_b32 v7, a200
    v_accvgpr_read_b32 v8, a201
    v_add_f32 v9, v9, v7
    v_add_f32 v10, v10, v8
    s_waitcnt vmcnt(9)
    v_accvgpr_read_b32 v7, a202
    v_accvgpr_read_b32 v8, a203
    v_add_f32 v9, v9, v7
    v_add_f32 v10, v10, v8
    s_waitcnt vmcnt(8)
    v_accvgpr_read_b32 v7, a204
    v_accvgpr_read_b32 v8, a205
    v_add_f32 v9, v9, v7
    v_add_f32 v10, v10, v8
    v_mov_b32 v7, v9
    s_nop 1
    v_permlane32_swap_b32 v9, v7
    v_add_f32 v9, v9, v7
    v_mov_b32 v7, v10
    s_nop 1
    v_permlane32_swap_b32 v10, v7
    v_add_f32 v10, v10, v7
    v_mul_f32 v15, 0x3b124925, v9
    v_mul_f32 v14, 0x3b124925, v10
    v_fma_f32 v14, -v15, v15, v14
    v_max_f32 v14, 0, v14
    v_cvt_pk_bf16_f32 v14, v14, v14
    v_lshlrev_b32 v14, 16, v14
    v_add_f32 v14, 0x3727c5ac, v14
    v_cvt_pk_bf16_f32 v14, v14, v14
    v_lshlrev_b32 v14, 16, v14
    v_sqrt_f32 v14, v14
    s_nop 0
    v_cvt_pk_bf16_f32 v14, v14, v14
    v_lshlrev_b32 v14, 16, v14
    v_mul_f32 v18, v14, v14
    v_rcp_f32 v14, v14
    v_sub_f32 v15, 0, v15
    v_mul_f32 v16, 0xc0135761, v14
    v_mul_f32 v17, v14, v14
    v_mul_f32 v17, v17, v16
    v_mul_f32 v17, 0x3d372713, v17
    v_cvt_pk_bf16_f32 v7, v15, v15
    v_cndmask_b32 v7, 0, v7, s[32:33]
    v_accvgpr_write_b32 a188, v7
    v_accvgpr_write_b32 a189, v7
    v_mfma_f32_32x32x16_bf16 v[160:175], a[228:231], v[128:131], v[160:175]
    s_add_u32 s35, s84, 272384
    buffer_load_dwordx4 a[152:155], v22, s[60:63], s35 offen
    ds_read_b128 a[228:231], v19 offset:55296
    s_waitcnt lgkmcnt(4)
    v_mfma_f32_32x32x16_bf16 v[176:191], a[232:235], v[128:131], v[176:191]
    ds_read_b128 a[232:235], v20 offset:26624
    v_mfma_f32_32x32x16_bf16 v[144:159], a[236:239], v[132:135], v[144:159]
    s_add_u32 s35, s84, 279552
    buffer_load_dwordx4 a[156:159], v22, s[60:63], s35 offen
    ds_read_b128 a[236:239], v19 offset:27648
    s_waitcnt lgkmcnt(4)
    v_mfma_f32_32x32x16_bf16 v[160:175], a[240:243], v[132:135], v[160:175]
    ds_read_b128 a[240:243], v19 offset:56320
    v_mfma_f32_32x32x16_bf16 v[176:191], a[244:247], v[132:135], v[176:191]
    ds_read_b128 a[244:247], v20 offset:27648
    s_waitcnt lgkmcnt(4)
    v_mfma_f32_32x32x16_bf16 v[144:159], a[224:227], v[136:139], v[144:159]
    s_barrier
    ds_read_b128 a[224:227], v20 offset:28672
    v_mfma_f32_32x32x16_bf16 v[160:175], a[228:231], v[136:139], v[160:175]
    ds_read_b128 a[228:231], v20 offset:29696
    s_waitcnt lgkmcnt(4)
    v_mfma_f32_32x32x16_bf16 v[176:191], a[232:235], v[136:139], v[176:191]
    ds_read_b128 a[232:235], v20 offset:30720
    v_mfma_f32_32x32x16_bf16 v[192:207], a[172:175], a[188:191], 0
    v_mfma_f32_32x32x16_bf16 v[208:223], a[176:179], a[188:191], 0
    v_mfma_f32_32x32x16_bf16 v[224:239], a[180:183], a[188:191], 0
    v_mfma_f32_32x32x16_bf16 v[240:255], a[184:187], a[188:191], 0
    v_mfma_f32_32x32x16_bf16 v[144:159], a[236:239], v[140:143], v[144:159]
    ds_read_b128 a[236:239], v20 offset:31744
    v_mfma_f32_32x32x16_bf16 v[144:159], a[160:163], a[188:191], v[144:159]
    s_waitcnt lgkmcnt(4)
    v_mfma_f32_32x32x16_bf16 v[160:175], a[240:243], v[140:143], v[160:175]
    ds_read_b128 a[240:243], v20 offset:32768
    v_mfma_f32_32x32x16_bf16 v[160:175], a[164:167], a[188:191], v[160:175]
    v_mfma_f32_32x32x16_bf16 v[176:191], a[244:247], v[140:143], v[176:191]
    ds_read_b128 a[244:247], v20 offset:33792
    v_mfma_f32_32x32x16_bf16 v[176:191], a[168:171], a[188:191], v[176:191]
    s_waitcnt lgkmcnt(4)
    v_mfma_f32_32x32x16_bf16 v[192:207], a[224:227], v[32:35], v[192:207]
    ds_read_b128 a[224:227], v20 offset:34816
    s_nop 1
    v_mul_f32 v9, v144, v144
    v_mul_f32 v10, v145, v145
    v_mul_f32 v11, v146, v146
    v_mul_f32 v12, v147, v147
    v_mfma_f32_32x32x16_bf16 v[192:207], a[228:231], v[36:39], v[192:207]
    s_barrier
    ds_read_b128 a[228:231], v20 offset:35840
    v_fma_f32 v9, v9, v17, v16
    v_fma_f32 v10, v10, v17, v16
    v_fma_f32 v11, v11, v17, v16
    v_fma_f32 v12, v12, v17, v16
    s_waitcnt lgkmcnt(4)
    v_mfma_f32_32x32x16_bf16 v[192:207], a[232:235], v[40:43], v[192:207]
    ds_read_b128 a[232:235], v20 offset:36864
    v_mul_f32 v152, v152, v144
    v_mul_f32 v153, v153, v145
    v_mul_f32 v154, v154, v146
    v_mul_f32 v155, v155, v147
    v_mfma_f32_32x32x16_bf16 v[192:207], a[236:239], v[44:47], v[192:207]
    ds_read_b128 a[236:239], v20 offset:37888
    v_mul_f32 v144, v144, v9
    v_mul_f32 v145, v145, v10
    v_mul_f32 v146, v146, v11
    v_mul_f32 v147, v147, v12
    s_waitcnt lgkmcnt(4)
    v_mfma_f32_32x32x16_bf16 v[192:207], a[240:243], v[48:51], v[192:207]
    ds_read_b128 a[240:243], v20 offset:38912
    v_mul_f32 v9, v148, v148
    v_mul_f32 v10, v149, v149
    v_mul_f32 v11, v150, v150
    v_mul_f32 v12, v151, v151
    v_mfma_f32_32x32x16_bf16 v[192:207], a[244:247], v[52:55], v[192:207]
    ds_read_b128 a[244:247], v20 offset:39936
    v_fma_f32 v9, v9, v17, v16
    v_fma_f32 v10, v10, v17, v16
    v_fma_f32 v11, v11, v17, v16
    v_fma_f32 v12, v12, v17, v16
    s_waitcnt lgkmcnt(4)
    v_mfma_f32_32x32x16_bf16 v[192:207], a[224:227], v[56:59], v[192:207]
    ds_read_b128 a[224:227], v20 offset:40960
    v_mul_f32 v156, v156, v148
    v_mul_f32 v157, v157, v149
    v_mul_f32 v158, v158, v150
    v_mul_f32 v159, v159, v151
    v_mfma_f32_32x32x16_bf16 v[192:207], a[228:231], v[60:63], v[192:207]
    ds_read_b128 a[228:231], v20 offset:41984
    v_mul_f32 v148, v148, v9
    v_mul_f32 v149, v149, v10
    v_mul_f32 v150, v150, v11
    v_mul_f32 v151, v151, v12
    s_waitcnt lgkmcnt(4)
    v_mfma_f32_32x32x16_bf16 v[192:207], a[232:235], v[64:67], v[192:207]
    ds_read_b128 a[232:235], v20 offset:43008
    v_exp_f32 v144, v144
    v_exp_f32 v145, v145
    v_mfma_f32_32x32x16_bf16 v[192:207], a[236:239], v[68:71], v[192:207]
    ds_read_b128 a[236:239], v20 offset:44032
    v_exp_f32 v146, v146
    v_exp_f32 v147, v147
    s_waitcnt lgkmcnt(4)
    v_mfma_f32_32x32x16_bf16 v[192:207], a[240:243], v[72:75], v[192:207]
    s_add_u32 s35, s36, 143360
    s_add_u32 m0, s37, 0
    s_nop 0
    buffer_load_dwordx4 v2, s[72:75], s35 offen offset:0 sc1 lds
    buffer_load_dwordx4 v2, s[72:75], s35 offen offset:1024 sc1 lds
    buffer_load_dwordx4 v2, s[72:75], s35 offen offset:2048 sc1 lds
    buffer_load_dwordx4 v2, s[72:75], s35 offen offset:3072 sc1 lds
    ds_read_b128 a[240:243], v20 offset:45056
    v_exp_f32 v148, v148
    v_exp_f32 v149, v149
    v_mfma_f32_32x32x16_bf16 v[192:207], a[244:247], v[76:79], v[192:207]
    ds_read_b128 a[244:247], v20 offset:46080
    v_exp_f32 v150, v150
    v_exp_f32 v151, v151
    s_waitcnt lgkmcnt(4)
    v_mfma_f32_32x32x16_bf16 v[192:207], a[224:227], v[80:83], v[192:207]
    ds_read_b128 a[224:227], v20 offset:47104
    v_fma_f32 v144, v144, v18, v18
    v_fma_f32 v145, v145, v18, v18
    v_fma_f32 v146, v146, v18, v18
    v_fma_f32 v147, v147, v18, v18
    v_mfma_f32_32x32x16_bf16 v[192:207], a[228:231], v[84:87], v[192:207]
    ds_read_b128 a[228:231], v20 offset:48128
    v_fma_f32 v148, v148, v18, v18
    v_fma_f32 v149, v149, v18, v18
    v_fma_f32 v150, v150, v18, v18
    v_fma_f32 v151, v151, v18, v18
    s_waitcnt lgkmcnt(4)
    v_mfma_f32_32x32x16_bf16 v[192:207], a[232:235], v[88:91], v[192:207]
    ds_read_b128 a[232:235], v20 offset:49152
    v_rcp_f32 v144, v144
    v_rcp_f32 v145, v145
    v_mfma_f32_32x32x16_bf16 v[192:207], a[236:239], v[92:95], v[192:207]
    ds_read_b128 a[236:239], v20 offset:50176
    v_rcp_f32 v146, v146
    v_rcp_f32 v147, v147
    s_waitcnt lgkmcnt(4)
    v_mfma_f32_32x32x16_bf16 v[192:207], a[240:243], v[96:99], v[192:207]
    ds_read_b128 a[240:243], v20 offset:51200
    v_rcp_f32 v148, v148
    v_rcp_f32 v149, v149
    v_mfma_f32_32x32x16_bf16 v[192:207], a[244:247], v[100:103], v[192:207]
    s_add_u32 s35, s36, 147456
    s_add_u32 m0, s37, 4096
    s_nop 0
    buffer_load_dwordx4 v2, s[72:75], s35 offen offset:0 sc1 lds
    buffer_load_dwordx4 v2, s[72:75], s35 offen offset:1024 sc1 lds
    buffer_load_dwordx4 v2, s[72:75], s35 offen offset:2048 sc1 lds
    ds_read_b128 a[244:247], v20 offset:52224
    v_rcp_f32 v150, v150
    v_rcp_f32 v151, v151
    s_waitcnt lgkmcnt(4)
    v_mfma_f32_32x32x16_bf16 v[192:207], a[224:227], v[104:107], v[192:207]
    ds_read_b128 a[224:227], v20 offset:53248
    v_mul_f32 v152, v152, v144
    v_mul_f32 v153, v153, v145
    v_mul_f32 v154, v154, v146
    v_mul_f32 v155, v155, v147
    v_mfma_f32_32x32x16_bf16 v[192:207], a[228:231], v[108:111], v[192:207]
    ds_read_b128 a[228:231], v20 offset:54272
    v_mul_f32 v156, v156, v148
    v_mul_f32 v157, v157, v149
    v_mul_f32 v158, v158, v150
    v_mul_f32 v159, v159, v151
    s_waitcnt lgkmcnt(4)
    v_mfma_f32_32x32x16_bf16 v[192:207], a[232:235], v[112:115], v[192:207]
    ds_read_b128 a[232:235], v20 offset:55296
    v_cvt_pk_bf16_f32 v144, v152, v153
    v_cvt_pk_bf16_f32 v145, v154, v155
    v_cvt_pk_bf16_f32 v146, v156, v157
    v_cvt_pk_bf16_f32 v147, v158, v159
    v_mfma_f32_32x32x16_bf16 v[192:207], a[236:239], v[116:119], v[192:207]
    ds_read_b128 a[236:239], v20 offset:56320
    s_add_u32 s9, s12, 0
    buffer_store_dwordx4 v[144:147], v2, s[72:75], s9 offen sc1
    v_mul_f32 v9, v160, v160
    v_mul_f32 v10, v161, v161
    v_mul_f32 v11, v162, v162
    s_waitcnt lgkmcnt(4)
    v_mfma_f32_32x32x16_bf16 v[192:207], a[240:243], v[120:123], v[192:207]
    s_barrier
    ds_read_b128 a[240:243], v21 offset:0
    v_mul_f32 v12, v163, v163
    v_fma_f32 v9, v9, v17, v16
    v_fma_f32 v10, v10, v17, v16
    v_fma_f32 v11, v11, v17, v16
    v_mfma_f32_32x32x16_bf16 v[192:207], a[244:247], v[124:127], v[192:207]
    ds_read_b128 a[244:247], v21 offset:1024
    v_fma_f32 v12, v12, v17, v16
    v_mul_f32 v168, v168, v160
    v_mul_f32 v169, v169, v161
    v_mul_f32 v170, v170, v162
    s_waitcnt lgkmcnt(4)
    v_mfma_f32_32x32x16_bf16 v[192:207], a[224:227], v[128:131], v[192:207]
    ds_read_b128 a[224:227], v21 offset:2048
    v_mul_f32 v171, v171, v163
    v_mul_f32 v160, v160, v9
    v_mul_f32 v161, v161, v10
    v_mul_f32 v162, v162, v11
    v_mfma_f32_32x32x16_bf16 v[192:207], a[228:231], v[132:135], v[192:207]
    s_add_u32 s35, s36, 172032
    s_add_u32 m0, s37, 28672
    s_nop 0
    buffer_load_dwordx4 v2, s[72:75], s35 offen offset:0 sc1 lds
    buffer_load_dwordx4 v2, s[72:75], s35 offen offset:1024 sc1 lds
    buffer_load_dwordx4 v2, s[72:75], s35 offen offset:2048 sc1 lds
    buffer_load_dwordx4 v2, s[72:75], s35 offen offset:3072 sc1 lds
    ds_read_b128 a[228:231], v21 offset:3072
    v_mul_f32 v163, v163, v12
    v_mul_f32 v9, v164, v164
    v_mul_f32 v10, v165, v165
    v_mul_f32 v11, v166, v166
    s_waitcnt lgkmcnt(4)
    v_mfma_f32_32x32x16_bf16 v[192:207], a[232:235], v[136:139], v[192:207]
    ds_read_b128 a[232:235], v21 offset:4096
    v_mul_f32 v12, v167, v167
    v_fma_f32 v9, v9, v17, v16
    v_fma_f32 v10, v10, v17, v16
    v_fma_f32 v11, v11, v17, v16
    v_mfma_f32_32x32x16_bf16 v[192:207], a[236:239], v[140:143], v[192:207]
    ds_read_b128 a[236:239], v21 offset:5120
    v_fma_f32 v12, v12, v17, v16
    v_mul_f32 v172, v172, v164
    v_mul_f32 v173, v173, v165
    v_mul_f32 v174, v174, v166
    s_waitcnt lgkmcnt(4)
    v_mfma_f32_32x32x16_bf16 v[208:223], a[240:243], v[32:35], v[208:223]
    ds_read_b128 a[240:243], v21 offset:6144
    v_mul_f32 v175, v175, v167
    v_mul_f32 v164, v164, v9
    v_mul_f32 v165, v165, v10
    v_mul_f32 v166, v166, v11
    v_mfma_f32_32x32x16_bf16 v[208:223], a[244:247], v[36:39], v[208:223]
    ds_read_b128 a[244:247], v21 offset:7168
    v_mul_f32 v167, v167, v12
    v_exp_f32 v160, v160
    v_exp_f32 v161, v161
    s_waitcnt lgkmcnt(4)
    v_mfma_f32_32x32x16_bf16 v[208:223], a[224:227], v[40:43], v[208:223]
    ds_read_b128 a[224:227], v21 offset:8192
    v_exp_f32 v162, v162
    v_exp_f32 v163, v163
    v_mfma_f32_32x32x16_bf16 v[208:223], a[228:231], v[44:47], v[208:223]
    ds_read_b128 a[228:231], v21 offset:9216
    v_exp_f32 v164, v164
    v_exp_f32 v165, v165
    s_waitcnt lgkmcnt(4)
    v_mfma_f32_32x32x16_bf16 v[208:223], a[232:235], v[48:51], v[208:223]
    s_add_u32 s35, s36, 176128
    s_add_u32 m0, s37, 32768
    s_nop 0
    buffer_load_dwordx4 v2, s[72:75], s35 offen offset:0 sc1 lds
    buffer_load_dwordx4 v2, s[72:75], s35 offen offset:1024 sc1 lds
    buffer_load_dwordx4 v2, s[72:75], s35 offen offset:2048 sc1 lds
    ds_read_b128 a[232:235], v21 offset:10240
    v_exp_f32 v166, v166
    v_exp_f32 v167, v167
    v_mfma_f32_32x32x16_bf16 v[208:223], a[236:239], v[52:55], v[208:223]
    ds_read_b128 a[236:239], v21 offset:11264
    v_fma_f32 v160, v160, v18, v18
    v_fma_f32 v161, v161, v18, v18
    v_fma_f32 v162, v162, v18, v18
    v_fma_f32 v163, v163, v18, v18
    s_waitcnt lgkmcnt(4)
    v_mfma_f32_32x32x16_bf16 v[208:223], a[240:243], v[56:59], v[208:223]
    ds_read_b128 a[240:243], v21 offset:12288
    v_fma_f32 v164, v164, v18, v18
    v_fma_f32 v165, v165, v18, v18
    v_fma_f32 v166, v166, v18, v18
    v_fma_f32 v167, v167, v18, v18
    v_mfma_f32_32x32x16_bf16 v[208:223], a[244:247], v[60:63], v[208:223]
    s_add_u32 s35, s84, 286720
    buffer_load_dwordx4 a[160:163], v22, s[60:63], s35 offen
    ds_read_b128 a[244:247], v21 offset:13312
    v_rcp_f32 v160, v160
    v_rcp_f32 v161, v161
    s_waitcnt lgkmcnt(4)
    v_mfma_f32_32x32x16_bf16 v[208:223], a[224:227], v[64:67], v[208:223]
    ds_read_b128 a[224:227], v21 offset:14336
    v_rcp_f32 v162, v162
    v_rcp_f32 v163, v163
    v_mfma_f32_32x32x16_bf16 v[208:223], a[228:231], v[68:71], v[208:223]
    s_add_u32 s35, s84, 293888
    buffer_load_dwordx4 a[164:167], v22, s[60:63], s35 offen
    ds_read_b128 a[228:231], v21 offset:15360
    v_rcp_f32 v164, v164
    v_rcp_f32 v165, v165
    s_waitcnt lgkmcnt(4)
    v_mfma_f32_32x32x16_bf16 v[208:223], a[232:235], v[72:75], v[208:223]
    ds_read_b128 a[232:235], v21 offset:16384
    v_rcp_f32 v166, v166
    v_rcp_f32 v167, v167
    v_mfma_f32_32x32x16_bf16 v[208:223], a[236:239], v[76:79], v[208:223]
    ds_read_b128 a[236:239], v21 offset:17408
    v_mul_f32 v168, v168, v160
    v_mul_f32 v169, v169, v161
    v_mul_f32 v170, v170, v162
    v_mul_f32 v171, v171, v163
    s_waitcnt lgkmcnt(4)
    v_mfma_f32_32x32x16_bf16 v[208:223], a[240:243], v[80:83], v[208:223]
    s_add_u32 s35, s84, 301056
    buffer_load_dwordx4 a[168:171], v22, s[60:63], s35 offen
    ds_read_b128 a[240:243], v21 offset:18432
    v_mul_f32 v172, v172, v164
    v_mul_f32 v173, v173, v165
    v_mul_f32 v174, v174, v166
    v_mul_f32 v175, v175, v167
    v_mfma_f32_32x32x16_bf16 v[208:223], a[244:247], v[84:87], v[208:223]
    ds_read_b128 a[244:247], v21 offset:19456
    v_cvt_pk_bf16_f32 v160, v168, v169
    v_cvt_pk_bf16_f32 v161, v170, v171
    v_cvt_pk_bf16_f32 v162, v172, v173
    v_cvt_pk_bf16_f32 v163, v174, v175
    s_waitcnt lgkmcnt(4)
    v_mfma_f32_32x32x16_bf16 v[208:223], a[224:227], v[88:91], v[208:223]
    s_add_u32 s35, s84, 308224
    buffer_load_dwordx4 a[172:175], v22, s[60:63], s35 offen
    ds_read_b128 a[224:227], v21 offset:20480
    s_add_u32 s9, s12, 1024
    buffer_store_dwordx4 v[160:163], v2, s[72:75], s9 offen sc1
    v_mul_f32 v9, v176, v176
    v_mul_f32 v10, v177, v177
    v_mul_f32 v11, v178, v178
    v_mfma_f32_32x32x16_bf16 v[208:223], a[228:231], v[92:95], v[208:223]
    ds_read_b128 a[228:231], v21 offset:21504
    v_mul_f32 v12, v179, v179
    v_fma_f32 v9, v9, v17, v16
    v_fma_f32 v10, v10, v17, v16
    v_fma_f32 v11, v11, v17, v16
    s_waitcnt lgkmcnt(4)
    v_mfma_f32_32x32x16_bf16 v[208:223], a[232:235], v[96:99], v[208:223]
    ds_read_b128 a[232:235], v21 offset:22528
    v_fma_f32 v12, v12, v17, v16
    v_mul_f32 v184, v184, v176
    v_mul_f32 v185, v185, v177
    v_mul_f32 v186, v186, v178
    v_mfma_f32_32x32x16_bf16 v[208:223], a[236:239], v[100:103], v[208:223]
    s_add_u32 s35, s84, 315392
    buffer_load_dwordx4 a[176:179], v22, s[60:63], s35 offen
    ds_read_b128 a[236:239], v21 offset:23552
    v_mul_f32 v187, v187, v179
    v_mul_f32 v176, v176, v9
    v_mul_f32 v177, v177, v10
    v_mul_f32 v178, v178, v11
    s_waitcnt lgkmcnt(4)
    v_mfma_f32_32x32x16_bf16 v[208:223], a[240:243], v[104:107], v[208:223]
    ds_read_b128 a[240:243], v21 offset:24576
    v_mul_f32 v179, v179, v12
    v_mul_f32 v9, v180, v180
    v_mul_f32 v10, v181, v181
    v_mul_f32 v11, v182, v182
    v_mfma_f32_32x32x16_bf16 v[208:223], a[244:247], v[108:111], v[208:223]
    s_add_u32 s35, s84, 322560
    buffer_load_dwordx4 a[180:183], v22, s[60:63], s35 offen
    ds_read_b128 a[244:247], v21 offset:25600
    v_mul_f32 v12, v183, v183
    v_fma_f32 v9, v9, v17, v16
    v_fma_f32 v10, v10, v17, v16
    v_fma_f32 v11, v11, v17, v16
    s_waitcnt lgkmcnt(4)
    v_mfma_f32_32x32x16_bf16 v[208:223], a[224:227], v[112:115], v[208:223]
    ds_read_b128 a[224:227], v21 offset:26624
    v_fma_f32 v12, v12, v17, v16
    v_mul_f32 v188, v188, v180
    v_mul_f32 v189, v189, v181
    v_mul_f32 v190, v190, v182
    v_mfma_f32_32x32x16_bf16 v[208:223], a[228:231], v[116:119], v[208:223]
    ds_read_b128 a[228:231], v21 offset:27648
    v_mul_f32 v191, v191, v183
    v_mul_f32 v180, v180, v9
    v_mul_f32 v181, v181, v10
    v_mul_f32 v182, v182, v11
    s_waitcnt lgkmcnt(4)
    v_mfma_f32_32x32x16_bf16 v[208:223], a[232:235], v[120:123], v[208:223]
    s_add_u32 s35, s84, 329728
    buffer_load_dwordx4 a[184:187], v22, s[60:63], s35 offen
    s_waitcnt vmcnt(16)
    s_barrier
    ds_read_b128 a[232:235], v19 offset:0
    v_mul_f32 v183, v183, v12
    v_exp_f32 v176, v176
    v_exp_f32 v177, v177
    v_mfma_f32_32x32x16_bf16 v[208:223], a[236:239], v[124:127], v[208:223]
    ds_read_b128 a[236:239], v19 offset:1024
    v_exp_f32 v178, v178
    v_exp_f32 v179, v179
    s_waitcnt lgkmcnt(4)
    v_mfma_f32_32x32x16_bf16 v[208:223], a[240:243], v[128:131], v[208:223]
    s_add_u32 s35, s84, 336896
    buffer_load_dwordx4 a[188:191], v22, s[60:63], s35 offen
    ds_read_b128 a[240:243], v19 offset:2048
    v_exp_f32 v180, v180
    v_exp_f32 v181, v181
    v_mfma_f32_32x32x16_bf16 v[208:223], a[244:247], v[132:135], v[208:223]
    ds_read_b128 a[244:247], v19 offset:3072
    v_exp_f32 v182, v182
    v_exp_f32 v183, v183
    s_waitcnt lgkmcnt(4)
    v_mfma_f32_32x32x16_bf16 v[208:223], a[224:227], v[136:139], v[208:223]
    ds_read_b128 a[224:227], v19 offset:4096
    v_fma_f32 v176, v176, v18, v18
    v_fma_f32 v177, v177, v18, v18
    v_fma_f32 v178, v178, v18, v18
    v_fma_f32 v179, v179, v18, v18
    v_mfma_f32_32x32x16_bf16 v[208:223], a[228:231], v[140:143], v[208:223]
    s_add_u32 s35, s84, 344064
    buffer_load_dwordx4 a[192:195], v22, s[60:63], s35 offen
    ds_read_b128 a[228:231], v19 offset:5120
    v_fma_f32 v180, v180, v18, v18
    v_fma_f32 v181, v181, v18, v18
    v_fma_f32 v182, v182, v18, v18
    v_fma_f32 v183, v183, v18, v18
    s_waitcnt lgkmcnt(4)
    v_mfma_f32_32x32x16_bf16 v[224:239], a[232:235], v[32:35], v[224:239]
    ds_read_b128 a[232:235], v19 offset:6144
    v_rcp_f32 v176, v176
    v_rcp_f32 v177, v177
    v_mfma_f32_32x32x16_bf16 v[224:239], a[236:239], v[36:39], v[224:239]
    s_add_u32 s35, s84, 351232
    buffer_load_dwordx4 a[196:199], v22, s[60:63], s35 offen
    ds_read_b128 a[236:239], v19 offset:7168
    v_rcp_f32 v178, v178
    v_rcp_f32 v179, v179
    s_waitcnt lgkmcnt(4)
    v_mfma_f32_32x32x16_bf16 v[224:239], a[240:243], v[40:43], v[224:239]
    ds_read_b128 a[240:243], v19 offset:8192
    v_rcp_f32 v180, v180
    v_rcp_f32 v181, v181
    v_mfma_f32_32x32x16_bf16 v[224:239], a[244:247], v[44:47], v[224:239]
    ds_read_b128 a[244:247], v19 offset:9216
    v_rcp_f32 v182, v182
    v_rcp_f32 v183, v183
    s_waitcnt lgkmcnt(4)
    v_mfma_f32_32x32x16_bf16 v[224:239], a[224:227], v[48:51], v[224:239]
    s_add_u32 s35, s84, 358400
    buffer_load_dwordx4 a[200:203], v22, s[60:63], s35 offen
    ds_read_b128 a[224:227], v19 offset:10240
    v_mul_f32 v184, v184, v176
    v_mul_f32 v185, v185, v177
    v_mul_f32 v186, v186, v178
    v_mul_f32 v187, v187, v179
    v_mfma_f32_32x32x16_bf16 v[224:239], a[228:231], v[52:55], v[224:239]
    ds_read_b128 a[228:231], v19 offset:11264
    v_mul_f32 v188, v188, v180
    v_mul_f32 v189, v189, v181
    v_mul_f32 v190, v190, v182
    v_mul_f32 v191, v191, v183
    s_waitcnt lgkmcnt(4)
    v_mfma_f32_32x32x16_bf16 v[224:239], a[232:235], v[56:59], v[224:239]
    s_add_u32 s35, s84, 365568
    buffer_load_dwordx4 a[204:207], v22, s[60:63], s35 offen
    ds_read_b128 a[232:235], v19 offset:12288
    v_cvt_pk_bf16_f32 v176, v184, v185
    v_cvt_pk_bf16_f32 v177, v186, v187
    v_cvt_pk_bf16_f32 v178, v188, v189
    v_cvt_pk_bf16_f32 v179, v190, v191
    v_mfma_f32_32x32x16_bf16 v[224:239], a[236:239], v[60:63], v[224:239]
    ds_read_b128 a[236:239], v19 offset:13312
    s_add_u32 s9, s12, 2048
    buffer_store_dwordx4 v[176:179], v2, s[72:75], s9 offen sc1
    v_mul_f32 v9, v192, v192
    v_mul_f32 v10, v193, v193
    v_mul_f32 v11, v194, v194
    s_waitcnt lgkmcnt(4)
    v_mfma_f32_32x32x16_bf16 v[224:239], a[240:243], v[64:67], v[224:239]
    ds_read_b128 a[240:243], v19 offset:14336
    v_mul_f32 v12, v195, v195
    v_fma_f32 v9, v9, v17, v16
    v_fma_f32 v10, v10, v17, v16
    v_fma_f32 v11, v11, v17, v16
    v_mfma_f32_32x32x16_bf16 v[224:239], a[244:247], v[68:71], v[224:239]
    s_add_u32 s35, s84, 372736
    buffer_load_dwordx4 a[208:211], v22, s[60:63], s35 offen
    ds_read_b128 a[244:247], v19 offset:15360
    v_fma_f32 v12, v12, v17, v16
    v_mul_f32 v200, v200, v192
    v_mul_f32 v201, v201, v193
    v_mul_f32 v202, v202, v194
    s_waitcnt lgkmcnt(4)
    v_mfma_f32_32x32x16_bf16 v[224:239], a[224:227], v[72:75], v[224:239]
    ds_read_b128 a[224:227], v19 offset:16384
    v_mul_f32 v203, v203, v195
    v_mul_f32 v192, v192, v9
    v_mul_f32 v193, v193, v10
    v_mul_f32 v194, v194, v11
    v_mfma_f32_32x32x16_bf16 v[224:239], a[228:231], v[76:79], v[224:239]
    s_add_u32 s35, s84, 379904
    buffer_load_dwordx4 a[212:215], v22, s[60:63], s35 offen
    ds_read_b128 a[228:231], v19 offset:17408
    v_mul_f32 v195, v195, v12
    v_mul_f32 v9, v196, v196
    v_mul_f32 v10, v197, v197
    v_mul_f32 v11, v198, v198
    s_waitcnt lgkmcnt(4)
    v_mfma_f32_32x32x16_bf16 v[224:239], a[232:235], v[80:83], v[224:239]
    ds_read_b128 a[232:235], v19 offset:18432
    v_mul_f32 v12, v199, v199
    v_fma_f32 v9, v9, v17, v16
    v_fma_f32 v10, v10, v17, v16
    v_fma_f32 v11, v11, v17, v16
    v_mfma_f32_32x32x16_bf16 v[224:239], a[236:239], v[84:87], v[224:239]
    ds_read_b128 a[236:239], v19 offset:19456
    v_fma_f32 v12, v12, v17, v16
    v_mul_f32 v204, v204, v196
    v_mul_f32 v205, v205, v197
    v_mul_f32 v206, v206, v198
    s_waitcnt lgkmcnt(4)
    v_mfma_f32_32x32x16_bf16 v[224:239], a[240:243], v[88:91], v[224:239]
    s_add_u32 s35, s84, 387072
    buffer_load_dwordx4 a[216:219], v22, s[60:63], s35 offen
    ds_read_b128 a[240:243], v19 offset:20480
    v_mul_f32 v207, v207, v199
    v_mul_f32 v196, v196, v9
    v_mul_f32 v197, v197, v10
    v_mul_f32 v198, v198, v11
    v_mfma_f32_32x32x16_bf16 v[224:239], a[244:247], v[92:95], v[224:239]
    ds_read_b128 a[244:247], v19 offset:21504
    v_mul_f32 v199, v199, v12
    v_exp_f32 v192, v192
    v_exp_f32 v193, v193
    s_waitcnt lgkmcnt(4)
    v_mfma_f32_32x32x16_bf16 v[224:239], a[224:227], v[96:99], v[224:239]
    s_add_u32 s35, s84, 394240
    buffer_load_dwordx4 a[220:223], v22, s[60:63], s35 offen
    ds_read_b128 a[224:227], v19 offset:22528
    v_exp_f32 v194, v194
    v_exp_f32 v195, v195
    v_mfma_f32_32x32x16_bf16 v[224:239], a[228:231], v[100:103], v[224:239]
    ds_read_b128 a[228:231], v19 offset:23552
    v_exp_f32 v196, v196
    v_exp_f32 v197, v197
    s_waitcnt lgkmcnt(4)
    v_mfma_f32_32x32x16_bf16 v[224:239], a[232:235], v[104:107], v[224:239]
    ds_read_b128 a[232:235], v19 offset:24576
    v_exp_f32 v198, v198
    v_exp_f32 v199, v199
    v_mfma_f32_32x32x16_bf16 v[224:239], a[236:239], v[108:111], v[224:239]
    ds_read_b128 a[236:239], v19 offset:25600
    v_fma_f32 v192, v192, v18, v18
    v_fma_f32 v193, v193, v18, v18
    v_fma_f32 v194, v194, v18, v18
    v_fma_f32 v195, v195, v18, v18
    s_waitcnt lgkmcnt(4)
    v_mfma_f32_32x32x16_bf16 v[224:239], a[240:243], v[112:115], v[224:239]
    ds_read_b128 a[240:243], v19 offset:26624
    v_fma_f32 v196, v196, v18, v18
    v_fma_f32 v197, v197, v18, v18
    v_fma_f32 v198, v198, v18, v18
    v_fma_f32 v199, v199, v18, v18
    v_mfma_f32_32x32x16_bf16 v[224:239], a[244:247], v[116:119], v[224:239]
    ds_read_b128 a[244:247], v19 offset:27648
    v_rcp_f32 v192, v192
    v_rcp_f32 v193, v193
    s_waitcnt lgkmcnt(4)
    v_mfma_f32_32x32x16_bf16 v[224:239], a[224:227], v[120:123], v[224:239]
    s_waitcnt vmcnt(18)
    s_barrier
    ds_read_b128 a[224:227], v19 offset:28672
    v_rcp_f32 v194, v194
    v_rcp_f32 v195, v195
    v_mfma_f32_32x32x16_bf16 v[224:239], a[228:231], v[124:127], v[224:239]
    ds_read_b128 a[228:231], v19 offset:29696
    v_rcp_f32 v196, v196
    v_rcp_f32 v197, v197
    s_waitcnt lgkmcnt(4)
    v_mfma_f32_32x32x16_bf16 v[224:239], a[232:235], v[128:131], v[224:239]
    ds_read_b128 a[232:235], v19 offset:30720
    v_rcp_f32 v198, v198
    v_rcp_f32 v199, v199
    v_mfma_f32_32x32x16_bf16 v[224:239], a[236:239], v[132:135], v[224:239]
    ds_read_b128 a[236:239], v19 offset:31744
    v_mul_f32 v200, v200, v192
    v_mul_f32 v201, v201, v193
    v_mul_f32 v202, v202, v194
    v_mul_f32 v203, v203, v195
    s_waitcnt lgkmcnt(4)
    v_mfma_f32_32x32x16_bf16 v[224:239], a[240:243], v[136:139], v[224:239]
    ds_read_b128 a[240:243], v19 offset:32768
    v_mul_f32 v204, v204, v196
    v_mul_f32 v205, v205, v197
    v_mul_f32 v206, v206, v198
    v_mul_f32 v207, v207, v199
    v_mfma_f32_32x32x16_bf16 v[224:239], a[244:247], v[140:143], v[224:239]
    ds_read_b128 a[244:247], v19 offset:33792
    v_cvt_pk_bf16_f32 v192, v200, v201
    v_cvt_pk_bf16_f32 v193, v202, v203
    v_cvt_pk_bf16_f32 v194, v204, v205
    v_cvt_pk_bf16_f32 v195, v206, v207
    s_waitcnt lgkmcnt(4)
    v_mfma_f32_32x32x16_bf16 v[240:255], a[224:227], v[32:35], v[240:255]
    ds_read_b128 a[224:227], v19 offset:34816
    s_add_u32 s9, s12, 3072
    buffer_store_dwordx4 v[192:195], v2, s[72:75], s9 offen sc1
    v_mul_f32 v9, v208, v208
    v_mul_f32 v10, v209, v209
    v_mul_f32 v11, v210, v210
    v_mfma_f32_32x32x16_bf16 v[240:255], a[228:231], v[36:39], v[240:255]
    ds_read_b128 a[228:231], v19 offset:35840
    v_mul_f32 v12, v211, v211
    v_fma_f32 v9, v9, v17, v16
    v_fma_f32 v10, v10, v17, v16
    v_fma_f32 v11, v11, v17, v16
    s_waitcnt lgkmcnt(4)
    v_mfma_f32_32x32x16_bf16 v[240:255], a[232:235], v[40:43], v[240:255]
    ds_read_b128 a[232:235], v19 offset:36864
    v_fma_f32 v12, v12, v17, v16
    v_mul_f32 v216, v216, v208
    v_mul_f32 v217, v217, v209
    v_mul_f32 v218, v218, v210
    v_mfma_f32_32x32x16_bf16 v[240:255], a[236:239], v[44:47], v[240:255]
    ds_read_b128 a[236:239], v19 offset:37888
    v_mul_f32 v219, v219, v211
    v_mul_f32 v208, v208, v9
    v_mul_f32 v209, v209, v10
    v_mul_f32 v210, v210, v11
    s_waitcnt lgkmcnt(4)
    v_mfma_f32_32x32x16_bf16 v[240:255], a[240:243], v[48:51], v[240:255]
    ds_read_b128 a[240:243], v19 offset:38912
    v_mul_f32 v211, v211, v12
    v_mul_f32 v9, v212, v212
    v_mul_f32 v10, v213, v213
    v_mul_f32 v11, v214, v214
    v_mfma_f32_32x32x16_bf16 v[240:255], a[244:247], v[52:55], v[240:255]
    ds_read_b128 a[244:247], v19 offset:39936
    v_mul_f32 v12, v215, v215
    v_fma_f32 v9, v9, v17, v16
    v_fma_f32 v10, v10, v17, v16
    v_fma_f32 v11, v11, v17, v16
    s_waitcnt lgkmcnt(4)
    v_mfma_f32_32x32x16_bf16 v[240:255], a[224:227], v[56:59], v[240:255]
    ds_read_b128 a[224:227], v19 offset:40960
    v_fma_f32 v12, v12, v17, v16
    v_mul_f32 v220, v220, v212
    v_mul_f32 v221, v221, v213
    v_mul_f32 v222, v222, v214
    v_mfma_f32_32x32x16_bf16 v[240:255], a[228:231], v[60:63], v[240:255]
    ds_read_b128 a[228:231], v19 offset:41984
    v_mul_f32 v223, v223, v215
    v_mul_f32 v212, v212, v9
    v_mul_f32 v213, v213, v10
    v_mul_f32 v214, v214, v11
    s_waitcnt lgkmcnt(4)
    v_mfma_f32_32x32x16_bf16 v[240:255], a[232:235], v[64:67], v[240:255]
    ds_read_b128 a[232:235], v19 offset:43008
    v_mul_f32 v215, v215, v12
    v_exp_f32 v208, v208
    v_exp_f32 v209, v209
    v_mfma_f32_32x32x16_bf16 v[240:255], a[236:239], v[68:71], v[240:255]
    ds_read_b128 a[236:239], v19 offset:44032
    v_exp_f32 v210, v210
    v_exp_f32 v211, v211
    s_waitcnt lgkmcnt(4)
    v_mfma_f32_32x32x16_bf16 v[240:255], a[240:243], v[72:75], v[240:255]
    ds_read_b128 a[240:243], v19 offset:45056
    v_exp_f32 v212, v212
    v_exp_f32 v213, v213
    v_mfma_f32_32x32x16_bf16 v[240:255], a[244:247], v[76:79], v[240:255]
    ds_read_b128 a[244:247], v19 offset:46080
    v_exp_f32 v214, v214
    v_exp_f32 v215, v215
    s_waitcnt lgkmcnt(4)
    v_mfma_f32_32x32x16_bf16 v[240:255], a[224:227], v[80:83], v[240:255]
    ds_read_b128 a[224:227], v19 offset:47104
    v_fma_f32 v208, v208, v18, v18
    v_fma_f32 v209, v209, v18, v18
    v_fma_f32 v210, v210, v18, v18
    v_fma_f32 v211, v211, v18, v18
    v_mfma_f32_32x32x16_bf16 v[240:255], a[228:231], v[84:87], v[240:255]
    ds_read_b128 a[228:231], v19 offset:48128
    v_fma_f32 v212, v212, v18, v18
    v_fma_f32 v213, v213, v18, v18
    v_fma_f32 v214, v214, v18, v18
    v_fma_f32 v215, v215, v18, v18
    s_waitcnt lgkmcnt(4)
    v_mfma_f32_32x32x16_bf16 v[240:255], a[232:235], v[88:91], v[240:255]
    ds_read_b128 a[232:235], v19 offset:49152
    v_rcp_f32 v208, v208
    v_rcp_f32 v209, v209
    v_mfma_f32_32x32x16_bf16 v[240:255], a[236:239], v[92:95], v[240:255]
    ds_read_b128 a[236:239], v19 offset:50176
    v_rcp_f32 v210, v210
    v_rcp_f32 v211, v211
    s_waitcnt lgkmcnt(4)
    v_mfma_f32_32x32x16_bf16 v[240:255], a[240:243], v[96:99], v[240:255]
    ds_read_b128 a[240:243], v19 offset:51200
    v_rcp_f32 v212, v212
    v_rcp_f32 v213, v213
    v_mfma_f32_32x32x16_bf16 v[240:255], a[244:247], v[100:103], v[240:255]
    ds_read_b128 a[244:247], v19 offset:52224
    v_rcp_f32 v214, v214
    v_rcp_f32 v215, v215
    s_waitcnt lgkmcnt(4)
    v_mfma_f32_32x32x16_bf16 v[240:255], a[224:227], v[104:107], v[240:255]
    ds_read_b128 a[224:227], v19 offset:53248
    v_mul_f32 v216, v216, v208
    v_mul_f32 v217, v217, v209
    v_mul_f32 v218, v218, v210
    v_mul_f32 v219, v219, v211
    v_mfma_f32_32x32x16_bf16 v[240:255], a[228:231], v[108:111], v[240:255]
    ds_read_b128 a[228:231], v19 offset:54272
    v_mul_f32 v220, v220, v212
    v_mul_f32 v221, v221, v213
    v_mul_f32 v222, v222, v214
    v_mul_f32 v223, v223, v215
    s_waitcnt lgkmcnt(4)
    v_mfma_f32_32x32x16_bf16 v[240:255], a[232:235], v[112:115], v[240:255]
    ds_read_b128 a[232:235], v19 offset:55296
    v_cvt_pk_bf16_f32 v208, v216, v217
    v_cvt_pk_bf16_f32 v209, v218, v219
    v_cvt_pk_bf16_f32 v210, v220, v221
    v_cvt_pk_bf16_f32 v211, v222, v223
    v_mfma_f32_32x32x16_bf16 v[240:255], a[236:239], v[116:119], v[240:255]
    ds_read_b128 a[236:239], v19 offset:56320
    s_add_u32 s9, s12, 4096
    buffer_store_dwordx4 v[208:211], v2, s[72:75], s9 offen sc1
    v_mul_f32 v9, v224, v224
    v_mul_f32 v10, v225, v225
    v_mul_f32 v11, v226, v226
    s_waitcnt lgkmcnt(4)
    v_mfma_f32_32x32x16_bf16 v[240:255], a[240:243], v[120:123], v[240:255]
    v_mul_f32 v12, v227, v227
    v_fma_f32 v9, v9, v17, v16
    v_fma_f32 v10, v10, v17, v16
    v_fma_f32 v11, v11, v17, v16
    v_mfma_f32_32x32x16_bf16 v[240:255], a[244:247], v[124:127], v[240:255]
    v_fma_f32 v12, v12, v17, v16
    v_mul_f32 v232, v232, v224
    v_mul_f32 v233, v233, v225
    v_mul_f32 v234, v234, v226
    s_waitcnt lgkmcnt(2)
    v_mfma_f32_32x32x16_bf16 v[240:255], a[224:227], v[128:131], v[240:255]
    v_mul_f32 v235, v235, v227
    v_mul_f32 v224, v224, v9
    v_mul_f32 v225, v225, v10
    v_mul_f32 v226, v226, v11
    v_mfma_f32_32x32x16_bf16 v[240:255], a[228:231], v[132:135], v[240:255]
    v_mul_f32 v227, v227, v12
    v_mul_f32 v9, v228, v228
    v_mul_f32 v10, v229, v229
    v_mul_f32 v11, v230, v230
    s_waitcnt lgkmcnt(0)
    v_mfma_f32_32x32x16_bf16 v[240:255], a[232:235], v[136:139], v[240:255]
    v_mul_f32 v12, v231, v231
    v_fma_f32 v9, v9, v17, v16
    v_fma_f32 v10, v10, v17, v16
    v_fma_f32 v11, v11, v17, v16
    v_mfma_f32_32x32x16_bf16 v[240:255], a[236:239], v[140:143], v[240:255]
    v_fma_f32 v12, v12, v17, v16
    v_mul_f32 v236, v236, v228
    v_mul_f32 v237, v237, v229
    v_mul_f32 v238, v238, v230
    v_mul_f32 v239, v239, v231
    v_mul_f32 v228, v228, v9
    v_mul_f32 v229, v229, v10
    v_mul_f32 v230, v230, v11
    v_mul_f32 v231, v231, v12
    v_exp_f32 v224, v224
    v_exp_f32 v225, v225
    v_exp_f32 v226, v226
    v_exp_f32 v227, v227
    v_exp_f32 v228, v228
    v_exp_f32 v229, v229
    v_exp_f32 v230, v230
    v_exp_f32 v231, v231
    v_fma_f32 v224, v224, v18, v18
    v_fma_f32 v225, v225, v18, v18
    v_fma_f32 v226, v226, v18, v18
    v_fma_f32 v227, v227, v18, v18
    v_fma_f32 v228, v228, v18, v18
    v_fma_f32 v229, v229, v18, v18
    v_fma_f32 v230, v230, v18, v18
    v_fma_f32 v231, v231, v18, v18
    v_rcp_f32 v224, v224
    v_rcp_f32 v225, v225
    v_rcp_f32 v226, v226
    v_rcp_f32 v227, v227
    v_rcp_f32 v228, v228
    v_rcp_f32 v229, v229
    v_rcp_f32 v230, v230
    v_rcp_f32 v231, v231
    v_mul_f32 v232, v232, v224
    v_mul_f32 v233, v233, v225
    v_mul_f32 v234, v234, v226
    v_mul_f32 v235, v235, v227
    v_mul_f32 v236, v236, v228
    v_mul_f32 v237, v237, v229
    v_mul_f32 v238, v238, v230
    v_mul_f32 v239, v239, v231
    v_cvt_pk_bf16_f32 v224, v232, v233
    v_cvt_pk_bf16_f32 v225, v234, v235
    v_cvt_pk_bf16_f32 v226, v236, v237
    v_cvt_pk_bf16_f32 v227, v238, v239
    s_add_u32 s9, s12, 5120
    buffer_store_dwordx4 v[224:227], v2, s[72:75], s9 offen sc1
    v_mul_f32 v9, v240, v240
    v_mul_f32 v10, v241, v241
    v_mul_f32 v11, v242, v242
    v_mul_f32 v12, v243, v243
    v_fma_f32 v9, v9, v17, v16
    v_fma_f32 v10, v10, v17, v16
    v_fma_f32 v11, v11, v17, v16
    v_fma_f32 v12, v12, v17, v16
    v_mul_f32 v248, v248, v240
    v_mul_f32 v249, v249, v241
    v_mul_f32 v250, v250, v242
    v_mul_f32 v251, v251, v243
    v_mul_f32 v240, v240, v9
    v_mul_f32 v241, v241, v10
    v_mul_f32 v242, v242, v11
    v_mul_f32 v243, v243, v12
    v_mul_f32 v9, v244, v244
    v_mul_f32 v10, v245, v245
    v_mul_f32 v11, v246, v246
    v_mul_f32 v12, v247, v247
    v_fma_f32 v9, v9, v17, v16
    v_fma_f32 v10, v10, v17, v16
    v_fma_f32 v11, v11, v17, v16
    v_fma_f32 v12, v12, v17, v16
    v_mul_f32 v252, v252, v244
    v_mul_f32 v253, v253, v245
    v_mul_f32 v254, v254, v246
    v_mul_f32 v255, v255, v247
    v_mul_f32 v244, v244, v9
    v_mul_f32 v245, v245, v10
    v_mul_f32 v246, v246, v11
    v_mul_f32 v247, v247, v12
    v_exp_f32 v240, v240
    v_exp_f32 v241, v241
    v_exp_f32 v242, v242
    v_exp_f32 v243, v243
    v_exp_f32 v244, v244
    v_exp_f32 v245, v245
    v_exp_f32 v246, v246
    v_exp_f32 v247, v247
    v_fma_f32 v240, v240, v18, v18
    v_fma_f32 v241, v241, v18, v18
    v_fma_f32 v242, v242, v18, v18
    v_fma_f32 v243, v243, v18, v18
    v_fma_f32 v244, v244, v18, v18
    v_fma_f32 v245, v245, v18, v18
    v_fma_f32 v246, v246, v18, v18
    v_fma_f32 v247, v247, v18, v18
    v_rcp_f32 v240, v240
    v_rcp_f32 v241, v241
    v_rcp_f32 v242, v242
    v_rcp_f32 v243, v243
    v_rcp_f32 v244, v244
    v_rcp_f32 v245, v245
    v_rcp_f32 v246, v246
    v_rcp_f32 v247, v247
    v_mul_f32 v248, v248, v240
    v_mul_f32 v249, v249, v241
    v_mul_f32 v250, v250, v242
    v_mul_f32 v251, v251, v243
    v_mul_f32 v252, v252, v244
    v_mul_f32 v253, v253, v245
    v_mul_f32 v254, v254, v246
    v_mul_f32 v255, v255, v247
    v_cvt_pk_bf16_f32 v240, v248, v249
    v_cvt_pk_bf16_f32 v241, v250, v251
    v_cvt_pk_bf16_f32 v242, v252, v253
    v_cvt_pk_bf16_f32 v243, v254, v255
    s_add_u32 s9, s12, 6144
    buffer_store_dwordx4 v[240:243], v2, s[72:75], s9 offen sc1
    s_waitcnt vmcnt(0)
    s_barrier
    s_cmp_lg_u32 s4, 0
    s_cbranch_scc1 L_sequential_preLN__linear_kernel_hedgehog__glu_gated_geglu__prompt_kernel_22
    s_mov_b64 s[30:31], exec
    s_mov_b64 exec, 1
    v_mov_b32 v7, 1
    buffer_atomic_add v7, off, s[72:75], s94 offset:8 sc1
    s_mov_b64 exec, s[30:31]
L_sequential_preLN__linear_kernel_hedgehog__glu_gated_geglu__prompt_kernel_22:
    s_cmp_ge_u32 s89, 14
    s_cbranch_scc1 L_fin
    s_mul_i32 s7, s4, 16384
    s_add_u32 s8, s7, 0
    v_bfe_u32 v7, v1, 2, 2
    v_lshlrev_b32 v9, 7, v7
    v_and_b32 v8, 3, v1
    v_lshl_add_u32 v9, v8, 3, v9
    v_bfe_u32 v8, v1, 4, 1
    v_lshl_add_u32 v9, v8, 5, v9
    v_bfe_u32 v8, v1, 3, 1
    v_lshlrev_b32 v8, 6, v8
    v_xor_b32 v9, v9, v8
    v_lshl_add_u32 v9, v4, 9, v9
    s_lshr_b32 s7, s4, 1
    s_lshl_b32 s7, s7, 6
    v_xor_b32 v9, s7, v9
    v_xor_b32 v10, 64, v9
    v_add_u32 v9, s8, v9
    v_add_u32 v10, s8, v10
    v_add_u32 v11, s8, v2
    ds_write_b128 v11, a[64:67] offset:0
    ds_write_b128 v11, a[68:71] offset:1024
    ds_read_b64_tr_b16 a[64:65], v9 offset:0
    ds_read_b64_tr_b16 a[66:67], v9 offset:1024
    ds_read_b64_tr_b16 a[68:69], v10 offset:0
    ds_read_b64_tr_b16 a[70:71], v10 offset:1024
    s_xor_b32 s7, s28, 0
    s_mul_i32 s13, s7, 114688
    s_mul_i32 s7, s4, 28672
    s_add_u32 s13, s13, s7
    s_add_u32 s13, s13, 0x1620000
    s_xor_b32 s7, s28, 1
    s_mul_i32 s14, s7, 114688
    s_mul_i32 s7, s4, 28672
    s_add_u32 s14, s14, s7
    s_add_u32 s14, s14, 0x1620000
    s_cmp_lg_u32 s4, 0
    s_cbranch_scc1 L_sequential_preLN__linear_kernel_hedgehog__glu_gated_geglu__prompt_kernel_23
    s_mov_b64 s[30:31], exec
    s_mov_b64 exec, 1
    s_mov_b32 s34, 0
L_sequential_preLN__linear_kernel_hedgehog__glu_gated_geglu__prompt_kernel_24:
    buffer_load_dword v7, off, s[72:75], s93 offset:8 sc1
    s_waitcnt vmcnt(0)
    v_readfirstlane_b32 s9, v7
    s_nop 0
    s_cmp_ge_u32 s9, 16
    s_cbranch_scc1 L_sequential_preLN__linear_kernel_hedgehog__glu_gated_geglu__prompt_kernel_25
    s_sleep 1
    s_add_u32 s34, s34, 1
    s_cmp_lt_u32 s34, 4194304
    s_cbranch_scc1 L_sequential_preLN__linear_kernel_hedgehog__glu_gated_geglu__prompt_kernel_24
L_sequential_preLN__linear_kernel_hedgehog__glu_gated_geglu__prompt_kernel_25:
    s_mov_b64 exec, s[30:31]
L_sequential_preLN__linear_kernel_hedgehog__glu_gated_geglu__prompt_kernel_23:
    s_waitcnt lgkmcnt(0)
    s_barrier
    buffer_load_dwordx4 v[96:99], v2, s[72:75], s13 offen offset:0 sc1
    buffer_load_dwordx4 v[100:103], v2, s[72:75], s14 offen offset:0 sc1
    buffer_load_dwordx4 v[104:107], v2, s[72:75], s13 offen offset:1024 sc1
    buffer_load_dwordx4 v[108:111], v2, s[72:75], s14 offen offset:1024 sc1
    buffer_load_dwordx4 v[112:115], v2, s[72:75], s13 offen offset:2048 sc1
    buffer_load_dwordx4 v[116:119], v2, s[72:75], s14 offen offset:2048 sc1
    buffer_load_dwordx4 v[120:123], v2, s[72:75], s13 offen offset:3072 sc1
    buffer_load_dwordx4 v[124:127], v2, s[72:75], s14 offen offset:3072 sc1
    s_add_u32 s13, s13, 4096
    s_add_u32 s14, s14, 4096
    buffer_load_dwordx4 v[128:131], v2, s[72:75], s13 offen offset:0 sc1
    buffer_load_dwordx4 v[132:135], v2, s[72:75], s14 offen offset:0 sc1
    buffer_load_dwordx4 v[136:139], v2, s[72:75], s13 offen offset:1024 sc1
    buffer_load_dwordx4 v[140:143], v2, s[72:75], s14 offen offset:1024 sc1
    buffer_load_dwordx4 v[144:147], v2, s[72:75], s13 offen offset:2048 sc1
    buffer_load_dwordx4 v[148:151], v2, s[72:75], s14 offen offset:2048 sc1
    buffer_load_dwordx4 v[152:155], v2, s[72:75], s13 offen offset:3072 sc1
    buffer_load_dwordx4 v[156:159], v2, s[72:75], s14 offen offset:3072 sc1
    s_add_u32 s13, s13, 4096
    s_add_u32 s14, s14, 4096
    buffer_load_dwordx4 v[160:163], v2, s[72:75], s13 offen offset:0 sc1
    buffer_load_dwordx4 v[164:167], v2, s[72:75], s14 offen offset:0 sc1
    buffer_load_dwordx4 v[168:171], v2, s[72:75], s13 offen offset:1024 sc1
    buffer_load_dwordx4 v[172:175], v2, s[72:75], s14 offen offset:1024 sc1
    buffer_load_dwordx4 v[176:179], v2, s[72:75], s13 offen offset:2048 sc1
    buffer_load_dwordx4 v[180:183], v2, s[72:75], s14 offen offset:2048 sc1
    ds_write_b128 v11, a[72:75] offset:2048
    ds_write_b128 v11, a[76:79] offset:3072
    ds_read_b64_tr_b16 a[72:73], v9 offset:2048
    ds_read_b64_tr_b16 a[74:75], v9 offset:3072
    ds_read_b64_tr_b16 a[76:77], v10 offset:2048
    ds_read_b64_tr_b16 a[78:79], v10 offset:3072
    s_waitcnt vmcnt(20)
    v_mfma_f32_32x32x16_bf16 v[32:47], a[0:3], v[96:99], 0
    v_mfma_f32_32x32x16_bf16 v[48:63], a[0:3], v[100:103], 0
    v_mfma_f32_32x32x16_bf16 v[64:79], a[4:7], v[96:99], 0
    v_mfma_f32_32x32x16_bf16 v[80:95], a[4:7], v[100:103], 0
    buffer_load_dwordx4 v[184:187], v2, s[72:75], s13 offen offset:3072 sc1
    buffer_load_dwordx4 v[188:191], v2, s[72:75], s14 offen offset:3072 sc1
    s_add_u32 s13, s13, 4096
    s_add_u32 s14, s14, 4096
    ds_write_b128 v11, a[80:83] offset:4096
    ds_write_b128 v11, a[84:87] offset:5120
    ds_read_b64_tr_b16 a[80:81], v9 offset:4096
    ds_read_b64_tr_b16 a[82:83], v9 offset:5120
    ds_read_b64_tr_b16 a[84:85], v10 offset:4096
    ds_read_b64_tr_b16 a[86:87], v10 offset:5120
    s_waitcnt vmcnt(20)
    v_mfma_f32_32x32x16_bf16 v[32:47], a[8:11], v[104:107], v[32:47]
    v_mfma_f32_32x32x16_bf16 v[48:63], a[8:11], v[108:111], v[48:63]
    v_mfma_f32_32x32x16_bf16 v[64:79], a[12:15], v[104:107], v[64:79]
    v_mfma_f32_32x32x16_bf16 v[80:95], a[12:15], v[108:111], v[80:95]
    buffer_load_dwordx4 v[192:195], v2, s[72:75], s13 offen offset:0 sc1
    buffer_load_dwordx4 v[196:199], v2, s[72:75], s14 offen offset:0 sc1
    ds_write_b128 v11, a[88:91] offset:6144
    ds_write_b128 v11, a[92:95] offset:7168
    ds_read_b64_tr_b16 a[88:89], v9 offset:6144
    ds_read_b64_tr_b16 a[90:91], v9 offset:7168
    ds_read_b64_tr_b16 a[92:93], v10 offset:6144
    ds_read_b64_tr_b16 a[94:95], v10 offset:7168
    s_waitcnt vmcnt(20)
    v_mfma_f32_32x32x16_bf16 v[32:47], a[16:19], v[112:115], v[32:47]
    v_mfma_f32_32x32x16_bf16 v[48:63], a[16:19], v[116:119], v[48:63]
    v_mfma_f32_32x32x16_bf16 v[64:79], a[20:23], v[112:115], v[64:79]
    v_mfma_f32_32x32x16_bf16 v[80:95], a[20:23], v[116:119], v[80:95]
    buffer_load_dwordx4 v[200:203], v2, s[72:75], s13 offen offset:1024 sc1
    buffer_load_dwordx4 v[204:207], v2, s[72:75], s14 offen offset:1024 sc1
    ds_write_b128 v11, a[96:99] offset:8192
    ds_write_b128 v11, a[100:103] offset:9216
    ds_read_b64_tr_b16 a[96:97], v9 offset:8192
    ds_read_b64_tr_b16 a[98:99], v9 offset:9216
    ds_read_b64_tr_b16 a[100:101], v10 offset:8192
    ds_read_b64_tr_b16 a[102:103], v10 offset:9216
    s_waitcnt vmcnt(20)
    v_mfma_f32_32x32x16_bf16 v[32:47], a[24:27], v[120:123], v[32:47]
    v_mfma_f32_32x32x16_bf16 v[48:63], a[24:27], v[124:127], v[48:63]
    v_mfma_f32_32x32x16_bf16 v[64:79], a[28:31], v[120:123], v[64:79]
    v_mfma_f32_32x32x16_bf16 v[80:95], a[28:31], v[124:127], v[80:95]
    buffer_load_dwordx4 v[208:211], v2, s[72:75], s13 offen offset:2048 sc1
    buffer_load_dwordx4 v[212:215], v2, s[72:75], s14 offen offset:2048 sc1
    ds_write_b128 v11, a[104:107] offset:10240
    ds_write_b128 v11, a[108:111] offset:11264
    ds_read_b64_tr_b16 a[104:105], v9 offset:10240
    ds_read_b64_tr_b16 a[106:107], v9 offset:11264
    ds_read_b64_tr_b16 a[108:109], v10 offset:10240
    ds_read_b64_tr_b16 a[110:111], v10 offset:11264
    s_waitcnt vmcnt(20)
    v_mfma_f32_32x32x16_bf16 v[32:47], a[32:35], v[128:131], v[32:47]
    v_mfma_f32_32x32x16_bf16 v[48:63], a[32:35], v[132:135], v[48:63]
    v_mfma_f32_32x32x16_bf16 v[64:79], a[36:39], v[128:131], v[64:79]
    v_mfma_f32_32x32x16_bf16 v[80:95], a[36:39], v[132:135], v[80:95]
    buffer_load_dwordx4 v[216:219], v2, s[72:75], s13 offen offset:3072 sc1
    buffer_load_dwordx4 v[220:223], v2, s[72:75], s14 offen offset:3072 sc1
    s_add_u32 s13, s13, 4096
    s_add_u32 s14, s14, 4096
    ds_write_b128 v11, a[112:115] offset:12288
    ds_write_b128 v11, a[116:119] offset:13312
    ds_read_b64_tr_b16 a[112:113], v9 offset:12288
    ds_read_b64_tr_b16 a[114:115], v9 offset:13312
    ds_read_b64_tr_b16 a[116:117], v10 offset:12288
    ds_read_b64_tr_b16 a[118:119], v10 offset:13312
    s_waitcnt vmcnt(20)
    v_mfma_f32_32x32x16_bf16 v[32:47], a[40:43], v[136:139], v[32:47]
    v_mfma_f32_32x32x16_bf16 v[48:63], a[40:43], v[140:143], v[48:63]
    v_mfma_f32_32x32x16_bf16 v[64:79], a[44:47], v[136:139], v[64:79]
    v_mfma_f32_32x32x16_bf16 v[80:95], a[44:47], v[140:143], v[80:95]
    buffer_load_dwordx4 v[224:227], v2, s[72:75], s13 offen offset:0 sc1
    buffer_load_dwordx4 v[228:231], v2, s[72:75], s14 offen offset:0 sc1
    ds_write_b128 v11, a[120:123] offset:14336
    ds_write_b128 v11, a[124:127] offset:15360
    ds_read_b64_tr_b16 a[120:121], v9 offset:14336
    ds_read_b64_tr_b16 a[122:123], v9 offset:15360
    ds_read_b64_tr_b16 a[124:125], v10 offset:14336
    ds_read_b64_tr_b16 a[126:127], v10 offset:15360
    s_waitcnt vmcnt(20)
    v_mfma_f32_32x32x16_bf16 v[32:47], a[48:51], v[144:147], v[32:47]
    v_mfma_f32_32x32x16_bf16 v[48:63], a[48:51], v[148:151], v[48:63]
    v_mfma_f32_32x32x16_bf16 v[64:79], a[52:55], v[144:147], v[64:79]
    v_mfma_f32_32x32x16_bf16 v[80:95], a[52:55], v[148:151], v[80:95]
    buffer_load_dwordx4 v[232:235], v2, s[72:75], s13 offen offset:1024 sc1
    buffer_load_dwordx4 v[236:239], v2, s[72:75], s14 offen offset:1024 sc1
    ds_write_b128 v11, a[128:131] offset:0
    ds_write_b128 v11, a[132:135] offset:1024
    ds_read_b64_tr_b16 a[128:129], v9 offset:0
    ds_read_b64_tr_b16 a[130:131], v9 offset:1024
    ds_read_b64_tr_b16 a[132:133], v10 offset:0
    ds_read_b64_tr_b16 a[134:135], v10 offset:1024
    s_waitcnt vmcnt(20)
    v_mfma_f32_32x32x16_bf16 v[32:47], a[56:59], v[152:155], v[32:47]
    v_mfma_f32_32x32x16_bf16 v[48:63], a[56:59], v[156:159], v[48:63]
    v_mfma_f32_32x32x16_bf16 v[64:79], a[60:63], v[152:155], v[64:79]
    v_mfma_f32_32x32x16_bf16 v[80:95], a[60:63], v[156:159], v[80:95]
    buffer_load_dwordx4 v[240:243], v2, s[72:75], s13 offen offset:2048 sc1
    buffer_load_dwordx4 v[244:247], v2, s[72:75], s14 offen offset:2048 sc1
    ds_write_b128 v11, a[136:139] offset:2048
    ds_write_b128 v11, a[140:143] offset:3072
    ds_read_b64_tr_b16 a[136:137], v9 offset:2048
    ds_read_b64_tr_b16 a[138:139], v9 offset:3072
    ds_read_b64_tr_b16 a[140:141], v10 offset:2048
    ds_read_b64_tr_b16 a[142:143], v10 offset:3072
    s_waitcnt vmcnt(20)
    v_mfma_f32_32x32x16_bf16 v[32:47], a[64:67], v[160:163], v[32:47]
    v_mfma_f32_32x32x16_bf16 v[48:63], a[64:67], v[164:167], v[48:63]
    v_mfma_f32_32x32x16_bf16 v[64:79], a[68:71], v[160:163], v[64:79]
    v_mfma_f32_32x32x16_bf16 v[80:95], a[68:71], v[164:167], v[80:95]
    buffer_load_dwordx4 v[248:251], v2, s[72:75], s13 offen offset:3072 sc1
    buffer_load_dwordx4 v[252:255], v2, s[72:75], s14 offen offset:3072 sc1
    s_add_u32 s13, s13, 4096
    s_add_u32 s14, s14, 4096
    ds_write_b128 v11, a[144:147] offset:4096
    ds_write_b128 v11, a[148:151] offset:5120
    ds_read_b64_tr_b16 a[144:145], v9 offset:4096
    ds_read_b64_tr_b16 a[146:147], v9 offset:5120
    ds_read_b64_tr_b16 a[148:149], v10 offset:4096
    ds_read_b64_tr_b16 a[150:151], v10 offset:5120
    s_waitcnt vmcnt(20) lgkmcnt(15)
    v_mfma_f32_32x32x16_bf16 v[32:47], a[72:75], v[168:171], v[32:47]
    v_mfma_f32_32x32x16_bf16 v[48:63], a[72:75], v[172:175], v[48:63]
    v_mfma_f32_32x32x16_bf16 v[64:79], a[76:79], v[168:171], v[64:79]
    v_mfma_f32_32x32x16_bf16 v[80:95], a[76:79], v[172:175], v[80:95]
    buffer_load_dwordx4 v[96:99], v2, s[72:75], s13 offen offset:0 sc1
    buffer_load_dwordx4 v[100:103], v2, s[72:75], s14 offen offset:0 sc1
    ds_write_b128 v11, a[152:155] offset:6144
    ds_write_b128 v11, a[156:159] offset:7168
    ds_read_b64_tr_b16 a[152:153], v9 offset:6144
    ds_read_b64_tr_b16 a[154:155], v9 offset:7168
    ds_read_b64_tr_b16 a[156:157], v10 offset:6144
    ds_read_b64_tr_b16 a[158:159], v10 offset:7168
    s_waitcnt vmcnt(20)
    v_mfma_f32_32x32x16_bf16 v[32:47], a[80:83], v[176:179], v[32:47]
    v_mfma_f32_32x32x16_bf16 v[48:63], a[80:83], v[180:183], v[48:63]
    v_mfma_f32_32x32x16_bf16 v[64:79], a[84:87], v[176:179], v[64:79]
    v_mfma_f32_32x32x16_bf16 v[80:95], a[84:87], v[180:183], v[80:95]
    buffer_load_dwordx4 v[104:107], v2, s[72:75], s13 offen offset:1024 sc1
    buffer_load_dwordx4 v[108:111], v2, s[72:75], s14 offen offset:1024 sc1
    ds_write_b128 v11, a[160:163] offset:8192
    ds_write_b128 v11, a[164:167] offset:9216
    ds_read_b64_tr_b16 a[160:161], v9 offset:8192
    ds_read_b64_tr_b16 a[162:163], v9 offset:9216
    ds_read_b64_tr_b16 a[164:165], v10 offset:8192
    ds_read_b64_tr_b16 a[166:167], v10 offset:9216
    s_waitcnt vmcnt(20)
    v_mfma_f32_32x32x16_bf16 v[32:47], a[88:91], v[184:187], v[32:47]
    v_mfma_f32_32x32x16_bf16 v[48:63], a[88:91], v[188:191], v[48:63]
    v_mfma_f32_32x32x16_bf16 v[64:79], a[92:95], v[184:187], v[64:79]
    v_mfma_f32_32x32x16_bf16 v[80:95], a[92:95], v[188:191], v[80:95]
    buffer_load_dwordx4 v[112:115], v2, s[72:75], s13 offen offset:2048 sc1
    buffer_load_dwordx4 v[116:119], v2, s[72:75], s14 offen offset:2048 sc1
    ds_write_b128 v11, a[168:171] offset:10240
    ds_write_b128 v11, a[172:175] offset:11264
    ds_read_b64_tr_b16 a[168:169], v9 offset:10240
    ds_read_b64_tr_b16 a[170:171], v9 offset:11264
    ds_read_b64_tr_b16 a[172:173], v10 offset:10240
    ds_read_b64_tr_b16 a[174:175], v10 offset:11264
    s_waitcnt vmcnt(20)
    v_mfma_f32_32x32x16_bf16 v[32:47], a[96:99], v[192:195], v[32:47]
    v_mfma_f32_32x32x16_bf16 v[48:63], a[96:99], v[196:199], v[48:63]
    v_mfma_f32_32x32x16_bf16 v[64:79], a[100:103], v[192:195], v[64:79]
    v_mfma_f32_32x32x16_bf16 v[80:95], a[100:103], v[196:199], v[80:95]
    buffer_load_dwordx4 v[120:123], v2, s[72:75], s13 offen offset:3072 sc1
    buffer_load_dwordx4 v[124:127], v2, s[72:75], s14 offen offset:3072 sc1
    s_add_u32 s13, s13, 4096
    s_add_u32 s14, s14, 4096
    ds_write_b128 v11, a[176:179] offset:12288
    ds_write_b128 v11, a[180:183] offset:13312
    ds_read_b64_tr_b16 a[176:177], v9 offset:12288
    ds_read_b64_tr_b16 a[178:179], v9 offset:13312
    ds_read_b64_tr_b16 a[180:181], v10 offset:12288
    ds_read_b64_tr_b16 a[182:183], v10 offset:13312
    s_waitcnt vmcnt(20)
    v_mfma_f32_32x32x16_bf16 v[32:47], a[104:107], v[200:203], v[32:47]
    v_mfma_f32_32x32x16_bf16 v[48:63], a[104:107], v[204:207], v[48:63]
    v_mfma_f32_32x32x16_bf16 v[64:79], a[108:111], v[200:203], v[64:79]
    v_mfma_f32_32x32x16_bf16 v[80:95], a[108:111], v[204:207], v[80:95]
    buffer_load_dwordx4 v[128:131], v2, s[72:75], s13 offen offset:0 sc1
    buffer_load_dwordx4 v[132:135], v2, s[72:75], s14 offen offset:0 sc1
    ds_write_b128 v11, a[184:187] offset:14336
    ds_write_b128 v11, a[188:191] offset:15360
    ds_read_b64_tr_b16 a[184:185], v9 offset:14336
    ds_read_b64_tr_b16 a[186:187], v9 offset:15360
    ds_read_b64_tr_b16 a[188:189], v10 offset:14336
    ds_read_b64_tr_b16 a[190:191], v10 offset:15360
    s_waitcnt vmcnt(20)
    v_mfma_f32_32x32x16_bf16 v[32:47], a[112:115], v[208:211], v[32:47]
    v_mfma_f32_32x32x16_bf16 v[48:63], a[112:115], v[212:215], v[48:63]
    v_mfma_f32_32x32x16_bf16 v[64:79], a[116:119], v[208:211], v[64:79]
    v_mfma_f32_32x32x16_bf16 v[80:95], a[116:119], v[212:215], v[80:95]
    buffer_load_dwordx4 v[136:139], v2, s[72:75], s13 offen offset:1024 sc1
    buffer_load_dwordx4 v[140:143], v2, s[72:75], s14 offen offset:1024 sc1
    ds_write_b128 v11, a[192:195] offset:0
    ds_write_b128 v11, a[196:199] offset:1024
    ds_read_b64_tr_b16 a[192:193], v9 offset:0
    ds_read_b64_tr_b16 a[194:195], v9 offset:1024
    ds_read_b64_tr_b16 a[196:197], v10 offset:0
    ds_read_b64_tr_b16 a[198:199], v10 offset:1024
    s_waitcnt vmcnt(20)
    v_mfma_f32_32x32x16_bf16 v[32:47], a[120:123], v[216:219], v[32:47]
    v_mfma_f32_32x32x16_bf16 v[48:63], a[120:123], v[220:223], v[48:63]
    v_mfma_f32_32x32x16_bf16 v[64:79], a[124:127], v[216:219], v[64:79]
    v_mfma_f32_32x32x16_bf16 v[80:95], a[124:127], v[220:223], v[80:95]
    buffer_load_dwordx4 v[144:147], v2, s[72:75], s13 offen offset:2048 sc1
    buffer_load_dwordx4 v[148:151], v2, s[72:75], s14 offen offset:2048 sc1
    ds_write_b128 v11, a[200:203] offset:2048
    ds_write_b128 v11, a[204:207] offset:3072
    ds_read_b64_tr_b16 a[200:201], v9 offset:2048
    ds_read_b64_tr_b16 a[202:203], v9 offset:3072
    ds_read_b64_tr_b16 a[204:205], v10 offset:2048
    ds_read_b64_tr_b16 a[206:207], v10 offset:3072
    s_waitcnt vmcnt(20) lgkmcnt(15)
    v_mfma_f32_32x32x16_bf16 v[32:47], a[128:131], v[224:227], v[32:47]
    v_mfma_f32_32x32x16_bf16 v[48:63], a[128:131], v[228:231], v[48:63]
    v_mfma_f32_32x32x16_bf16 v[64:79], a[132:135], v[224:227], v[64:79]
    v_mfma_f32_32x32x16_bf16 v[80:95], a[132:135], v[228:231], v[80:95]
    buffer_load_dwordx4 v[152:155], v2, s[72:75], s13 offen offset:3072 sc1
    buffer_load_dwordx4 v[156:159], v2, s[72:75], s14 offen offset:3072 sc1
    s_add_u32 s13, s13, 4096
    s_add_u32 s14, s14, 4096
    ds_write_b128 v11, a[208:211] offset:4096
    ds_write_b128 v11, a[212:215] offset:5120
    ds_read_b64_tr_b16 a[208:209], v9 offset:4096
    ds_read_b64_tr_b16 a[210:211], v9 offset:5120
    ds_read_b64_tr_b16 a[212:213], v10 offset:4096
    ds_read_b64_tr_b16 a[214:215], v10 offset:5120
    s_waitcnt vmcnt(20)
    v_mfma_f32_32x32x16_bf16 v[32:47], a[136:139], v[232:235], v[32:47]
    v_mfma_f32_32x32x16_bf16 v[48:63], a[136:139], v[236:239], v[48:63]
    v_mfma_f32_32x32x16_bf16 v[64:79], a[140:143], v[232:235], v[64:79]
    v_mfma_f32_32x32x16_bf16 v[80:95], a[140:143], v[236:239], v[80:95]
    ds_write_b128 v11, a[216:219] offset:6144
    ds_write_b128 v11, a[220:223] offset:7168
    ds_read_b64_tr_b16 a[216:217], v9 offset:6144
    ds_read_b64_tr_b16 a[218:219], v9 offset:7168
    ds_read_b64_tr_b16 a[220:221], v10 offset:6144
    ds_read_b64_tr_b16 a[222:223], v10 offset:7168
    s_waitcnt vmcnt(18)
    v_mfma_f32_32x32x16_bf16 v[32:47], a[144:147], v[240:243], v[32:47]
    v_mfma_f32_32x32x16_bf16 v[48:63], a[144:147], v[244:247], v[48:63]
    v_mfma_f32_32x32x16_bf16 v[64:79], a[148:151], v[240:243], v[64:79]
    v_mfma_f32_32x32x16_bf16 v[80:95], a[148:151], v[244:247], v[80:95]
    s_waitcnt vmcnt(16)
    v_mfma_f32_32x32x16_bf16 v[32:47], a[152:155], v[248:251], v[32:47]
    v_mfma_f32_32x32x16_bf16 v[48:63], a[152:155], v[252:255], v[48:63]
    v_mfma_f32_32x32x16_bf16 v[64:79], a[156:159], v[248:251], v[64:79]
    v_mfma_f32_32x32x16_bf16 v[80:95], a[156:159], v[252:255], v[80:95]
    s_waitcnt vmcnt(14)
    v_mfma_f32_32x32x16_bf16 v[32:47], a[160:163], v[96:99], v[32:47]
    v_mfma_f32_32x32x16_bf16 v[48:63], a[160:163], v[100:103], v[48:63]
    v_mfma_f32_32x32x16_bf16 v[64:79], a[164:167], v[96:99], v[64:79]
    v_mfma_f32_32x32x16_bf16 v[80:95], a[164:167], v[100:103], v[80:95]
    s_waitcnt vmcnt(12)
    v_mfma_f32_32x32x16_bf16 v[32:47], a[168:171], v[104:107], v[32:47]
    v_mfma_f32_32x32x16_bf16 v[48:63], a[168:171], v[108:111], v[48:63]
    v_mfma_f32_32x32x16_bf16 v[64:79], a[172:175], v[104:107], v[64:79]
    v_mfma_f32_32x32x16_bf16 v[80:95], a[172:175], v[108:111], v[80:95]
    s_waitcnt vmcnt(10)
    v_mfma_f32_32x32x16_bf16 v[32:47], a[176:179], v[112:115], v[32:47]
    v_mfma_f32_32x32x16_bf16 v[48:63], a[176:179], v[116:119], v[48:63]
    v_mfma_f32_32x32x16_bf16 v[64:79], a[180:183], v[112:115], v[64:79]
    v_mfma_f32_32x32x16_bf16 v[80:95], a[180:183], v[116:119], v[80:95]
    s_waitcnt vmcnt(8) lgkmcnt(15)
    v_mfma_f32_32x32x16_bf16 v[32:47], a[184:187], v[120:123], v[32:47]
    v_mfma_f32_32x32x16_bf16 v[48:63], a[184:187], v[124:127], v[48:63]
    v_mfma_f32_32x32x16_bf16 v[64:79], a[188:191], v[120:123], v[64:79]
    v_mfma_f32_32x32x16_bf16 v[80:95], a[188:191], v[124:127], v[80:95]
    s_waitcnt vmcnt(6)
    v_mfma_f32_32x32x16_bf16 v[32:47], a[192:195], v[128:131], v[32:47]
    v_mfma_f32_32x32x16_bf16 v[48:63], a[192:195], v[132:135], v[48:63]
    v_mfma_f32_32x32x16_bf16 v[64:79], a[196:199], v[128:131], v[64:79]
    v_mfma_f32_32x32x16_bf16 v[80:95], a[196:199], v[132:135], v[80:95]
    s_waitcnt vmcnt(4) lgkmcnt(12)
    v_mfma_f32_32x32x16_bf16 v[32:47], a[200:203], v[136:139], v[32:47]
    v_mfma_f32_32x32x16_bf16 v[48:63], a[200:203], v[140:143], v[48:63]
    v_mfma_f32_32x32x16_bf16 v[64:79], a[204:207], v[136:139], v[64:79]
    v_mfma_f32_32x32x16_bf16 v[80:95], a[204:207], v[140:143], v[80:95]
    s_waitcnt vmcnt(2) lgkmcnt(6)
    v_mfma_f32_32x32x16_bf16 v[32:47], a[208:211], v[144:147], v[32:47]
    v_mfma_f32_32x32x16_bf16 v[48:63], a[208:211], v[148:151], v[48:63]
    v_mfma_f32_32x32x16_bf16 v[64:79], a[212:215], v[144:147], v[64:79]
    v_mfma_f32_32x32x16_bf16 v[80:95], a[212:215], v[148:151], v[80:95]
    s_waitcnt vmcnt(0) lgkmcnt(0)
    v_mfma_f32_32x32x16_bf16 v[48:63], a[216:219], v[156:159], v[48:63]
    v_mfma_f32_32x32x16_bf16 v[64:79], a[220:223], v[152:155], v[64:79]
    v_mfma_f32_32x32x16_bf16 v[80:95], a[220:223], v[156:159], v[80:95]
    v_mfma_f32_32x32x16_bf16 v[32:47], a[216:219], v[152:155], v[32:47]
    s_xor_b32 s7, s4, 1
    s_mul_i32 s7, s7, 12288
    s_add_u32 s7, s7, 86016
    v_add_u32 v7, s7, v2
    s_nop 4
    ds_write_b128 v7, v[48:51] offset:0
    ds_write_b128 v7, v[52:55] offset:1024
    ds_write_b128 v7, v[56:59] offset:2048
    ds_write_b128 v7, v[60:63] offset:3072
    s_xor_b32 s7, s4, 2
    s_mul_i32 s7, s7, 12288
    s_add_u32 s7, s7, 90112
    v_add_u32 v7, s7, v2
    ds_write_b128 v7, v[64:67] offset:0
    ds_write_b128 v7, v[68:71] offset:1024
    ds_write_b128 v7, v[72:75] offset:2048
    ds_write_b128 v7, v[76:79] offset:3072
    s_xor_b32 s7, s4, 3
    s_mul_i32 s7, s7, 12288
    s_add_u32 s7, s7, 94208
    v_add_u32 v7, s7, v2
    ds_write_b128 v7, v[80:83] offset:0
    ds_write_b128 v7, v[84:87] offset:1024
    ds_write_b128 v7, v[88:91] offset:2048
    ds_write_b128 v7, v[92:95] offset:3072
    s_mul_i32 s7, s4, 12288
    s_add_u32 s7, s7, 86016
    v_add_u32 v7, s7, v2
    s_waitcnt lgkmcnt(0)
    s_barrier
    ds_read_b128 v[96:99], v7 offset:0
    ds_read_b128 v[100:103], v7 offset:1024
    ds_read_b128 v[104:107], v7 offset:2048
    ds_read_b128 v[108:111], v7 offset:3072
    ds_read_b128 v[112:115], v7 offset:4096
    ds_read_b128 v[116:119], v7 offset:5120
    ds_read_b128 v[120:123], v7 offset:6144
    ds_read_b128 v[124:127], v7 offset:7168
    ds_read_b128 v[128:131], v7 offset:8192
    ds_read_b128 v[132:135], v7 offset:9216
    ds_read_b128 v[136:139], v7 offset:10240
    ds_read_b128 v[140:143], v7 offset:11264
    s_waitcnt lgkmcnt(11)
    v_pk_add_f32 v[32:33], v[32:33], v[96:97]
    v_pk_add_f32 v[34:35], v[34:35], v[98:99]
    s_waitcnt lgkmcnt(10)
    v_pk_add_f32 v[36:37], v[36:37], v[100:101]
    v_pk_add_f32 v[38:39], v[38:39], v[102:103]
    s_waitcnt lgkmcnt(9)
    v_pk_add_f32 v[40:41], v[40:41], v[104:105]
    v_pk_add_f32 v[42:43], v[42:43], v[106:107]
    s_waitcnt lgkmcnt(8)
    v_pk_add_f32 v[44:45], v[44:45], v[108:109]
    v_pk_add_f32 v[46:47], v[46:47], v[110:111]
    s_waitcnt lgkmcnt(7)
    v_pk_add_f32 v[32:33], v[32:33], v[112:113]
    v_pk_add_f32 v[34:35], v[34:35], v[114:115]
    s_waitcnt lgkmcnt(6)
    v_pk_add_f32 v[36:37], v[36:37], v[116:117]
    v_pk_add_f32 v[38:39], v[38:39], v[118:119]
    s_waitcnt lgkmcnt(5)
    v_pk_add_f32 v[40:41], v[40:41], v[120:121]
    v_pk_add_f32 v[42:43], v[42:43], v[122:123]
    s_waitcnt lgkmcnt(4)
    v_pk_add_f32 v[44:45], v[44:45], v[124:125]
    v_pk_add_f32 v[46:47], v[46:47], v[126:127]
    s_waitcnt lgkmcnt(3)
    v_pk_add_f32 v[32:33], v[32:33], v[128:129]
    v_pk_add_f32 v[34:35], v[34:35], v[130:131]
    s_waitcnt lgkmcnt(2)
    v_pk_add_f32 v[36:37], v[36:37], v[132:133]
    v_pk_add_f32 v[38:39], v[38:39], v[134:135]
    s_waitcnt lgkmcnt(1)
    v_pk_add_f32 v[40:41], v[40:41], v[136:137]
    v_pk_add_f32 v[42:43], v[42:43], v[138:139]
    s_waitcnt lgkmcnt(0)
    v_pk_add_f32 v[44:45], v[44:45], v[140:141]
    v_pk_add_f32 v[46:47], v[46:47], v[142:143]
    v_cvt_pk_bf16_f32 v96, v32, v33
    v_cvt_pk_bf16_f32 v97, v34, v35
    v_cvt_pk_bf16_f32 v98, v36, v37
    v_cvt_pk_bf16_f32 v99, v38, v39
    v_cvt_pk_bf16_f32 v100, v40, v41
    v_cvt_pk_bf16_f32 v101, v42, v43
    v_cvt_pk_bf16_f32 v102, v44, v45
    v_cvt_pk_bf16_f32 v103, v46, v47
    v_lshlrev_b32 v32, 16, v96
    v_and_b32 v33, 0xffff0000, v96
    v_lshlrev_b32 v34, 16, v97
    v_and_b32 v35, 0xffff0000, v97
    v_lshlrev_b32 v36, 16, v98
    v_and_b32 v37, 0xffff0000, v98
    v_lshlrev_b32 v38, 16, v99
    v_and_b32 v39, 0xffff0000, v99
    v_lshlrev_b32 v40, 16, v100
    v_and_b32 v41, 0xffff0000, v100
    v_lshlrev_b32 v42, 16, v101
    v_and_b32 v43, 0xffff0000, v101
    v_lshlrev_b32 v44, 16, v102
    v_and_b32 v45, 0xffff0000, v102
    v_lshlrev_b32 v46, 16, v103
    v_and_b32 v47, 0xffff0000, v103
    v_dot2c_f32_bf16 v32, s18, v24
    v_dot2c_f32_bf16 v33, s19, v24
    v_dot2c_f32_bf16 v34, s18, v25
    v_dot2c_f32_bf16 v35, s19, v25
    v_dot2c_f32_bf16 v36, s18, v26
    v_dot2c_f32_bf16 v37, s19, v26
    v_dot2c_f32_bf16 v38, s18, v27
    v_dot2c_f32_bf16 v39, s19, v27
    v_dot2c_f32_bf16 v40, s18, v28
    v_dot2c_f32_bf16 v41, s19, v28
    v_dot2c_f32_bf16 v42, s18, v29
    v_dot2c_f32_bf16 v43, s19, v29
    v_dot2c_f32_bf16 v44, s18, v30
    v_dot2c_f32_bf16 v45, s19, v30
    v_dot2c_f32_bf16 v46, s18, v31
    v_dot2c_f32_bf16 v47, s19, v31
    v_cvt_pk_bf16_f32 v112, v32, v33
    v_cvt_pk_bf16_f32 v113, v34, v35
    v_cvt_pk_bf16_f32 v114, v36, v37
    v_cvt_pk_bf16_f32 v115, v38, v39
    v_cvt_pk_bf16_f32 v116, v40, v41
    v_cvt_pk_bf16_f32 v117, v42, v43
    v_cvt_pk_bf16_f32 v118, v44, v45
    v_cvt_pk_bf16_f32 v119, v46, v47
    s_mul_i32 s7, s4, 2560
    v_mul_u32_u24 v9, 80, v3
    v_lshl_add_u32 v9, v4, 3, v9
    v_add_u32 v9, s7, v9
    ds_write_b64 v9, v[112:113] offset:0
    ds_write_b64 v9, v[114:115] offset:16
    ds_write_b64 v9, v[116:117] offset:32
    ds_write_b64 v9, v[118:119] offset:48
    v_lshrrev_b32 v7, 2, v1
    v_and_b32 v8, 3, v1
    v_mul_u32_u24 v10, 80, v7
    v_lshl_add_u32 v10, v8, 4, v10
    v_add_u32 v10, s7, v10
    v_mul_u32_u24 v7, 896, v7
    v_lshl_add_u32 v7, v8, 4, v7
    ds_read_b128 v[32:35], v10 offset:0
    ds_read_b128 v[36:39], v10 offset:1280
    s_add_u32 s9, s85, 0
    s_waitcnt lgkmcnt(1)
    buffer_store_dwordx4 v[32:35], v7, s[64:67], s9 offen sc1
    s_add_u32 s9, s85, 14336
    s_waitcnt lgkmcnt(0)
    buffer_store_dwordx4 v[36:39], v7, s[64:67], s9 offen sc1
L_fin:
    s_nop 7
    s_nop 3
L_end:
    s_endpgm
.section .rodata,"a"
.p2align 6
.amdhsa_kernel sequential_preLN__linear_kernel_hedgehog__glu_gated_geglu__prompt_kernel
  .amdhsa_next_free_vgpr 512
  .amdhsa_next_free_sgpr 100
  .amdhsa_accum_offset 256
  .amdhsa_group_segment_fixed_size 0
  .amdhsa_kernarg_size 88
  .amdhsa_user_sgpr_count 2
  .amdhsa_user_sgpr_kernarg_segment_ptr 1
  .amdhsa_system_sgpr_workgroup_id_x 1
  .amdhsa_float_denorm_mode_32 3
  .amdhsa_float_denorm_mode_16_64 3
.end_amdhsa_kernel
```
